```python
import torch

def _softmax(x, axis=-1):
    return torch.softmax(x, dim=axis)

def _gelu(x):
    return torch.nn.functional.gelu(x, approximate='tanh')

def _silu(x):
    return torch.nn.functional.silu(x)

def _sigmoid(x):
    return torch.sigmoid(x)

def _layernorm(x, axis=-1, eps=1e-05):
    m = x.mean(dim=axis, keepdim=True)
    v = x.var(dim=axis, keepdim=True, unbiased=False)
    return (x - m) / torch.sqrt(v + eps)

def _scatter_add(tgt, idx, src, axis=0):
    return tgt.clone().index_add_(axis, idx, src)

def _segment_sum(src, seg, n):
    out = torch.zeros((n,) + src.shape[1:], dtype=src.dtype)
    return out.index_add_(0, seg, src)

def _pad(x, pw):
    flat = tuple((v for pair in reversed(pw) for v in pair))
    return torch.nn.functional.pad(x, flat)
kernel_name = 'adaLN_cond__ssm_conv_s4d__glu_gated_swiglu__prompt'

def setup_inputs():

    _w = lambda a: (lambda t: t.to(torch.bfloat16) if t.is_floating_point() else t)(torch.as_tensor(a))

    def _A_setup():
        Bsz, L, D, N = (1, 2048, 640, 128)
        return {'u': _w((lambda *s: torch.randn(*s, dtype=torch.bfloat16) * 0.05)(Bsz, L, D)), 'log_A_real': _w((lambda *s: torch.randn(*s, dtype=torch.bfloat16) * 3.2)(D, N) * 0.5), 'A_imag': _w((lambda *s: torch.randn(*s, dtype=torch.bfloat16) * 0.05)(D, N) * 3.14), 'C_real': _w((lambda *s: torch.randn(*s, dtype=torch.bfloat16) * 0.2)(D, N) / N ** 0.5), 'C_imag': _w((lambda *s: torch.randn(*s, dtype=torch.bfloat16) * 0.2)(D, N) / N ** 0.5), 'log_dt': _w((lambda *s: torch.randn(*s, dtype=torch.bfloat16) * 0.05)(D) * 0.5 - 4.0), 'D_skip': _w((lambda *s: torch.randn(*s, dtype=torch.bfloat16) * 0.05)(D))}
    _A_in = _A_setup()

    def _B_setup():
        B, S, D, F = (1, 2048, 640, 1728)
        return {'x': _w((lambda *s: torch.randn(*s, dtype=torch.bfloat16) * 0.05)(B, S, D)), 'w1': _w((lambda *s: torch.randn(*s, dtype=torch.bfloat16) * 0.4)(D, F) * (2.0 / D) ** 0.5), 'w3': _w((lambda *s: torch.randn(*s, dtype=torch.bfloat16) * 0.4)(D, F) * (2.0 / D) ** 0.5), 'w2': _w((lambda *s: torch.randn(*s, dtype=torch.bfloat16) * 0.4)(F, D) * (2.0 / F) ** 0.5)}
    _B_in = _B_setup()
    return {'A_u': _A_in['u'], 'A_log_A_real': _A_in['log_A_real'], 'A_A_imag': _A_in['A_imag'], 'A_C_real': _A_in['C_real'], 'A_C_imag': _A_in['C_imag'], 'A_log_dt': _A_in['log_dt'], 'A_D_skip': _A_in['D_skip'], 'B_x': _B_in['x'], 'B_w1': _B_in['w1'], 'B_w3': _B_in['w3'], 'B_w2': _B_in['w2'], 'c': _w((lambda *s: torch.randn(*s, dtype=torch.bfloat16) * 0.2)(1, 640) * 8.0), 'w_mod': _w((lambda *s: torch.randn(*s, dtype=torch.bfloat16) * 0.2)(640, 6 * 640) * 640 ** (-0.5) * 8.0)}

def reference(A_u, A_log_A_real, A_A_imag, A_C_real, A_C_imag, A_log_dt, A_D_skip, B_x, B_w1, B_w3, B_w2, c, w_mod):

    def _A_ref(u, log_A_real, A_imag, C_real, C_imag, log_dt, D_skip):
        L = u.shape[1]
        dt = torch.exp(log_dt)
        A = -torch.exp(log_A_real) + 1j * A_imag
        C = (C_real + 1j * C_imag) * dt[:, None]
        pos = (lambda x, dt: x.to(dt))(torch.arange(L), log_dt.dtype)
        P = torch.exp((A * dt[:, None])[:, :, None] * pos[None, None, :])
        K = 2.0 * torch.einsum('dn,dnl->dl', C, P).real
        L2 = 2 * L
        u_t = (lambda x, *d: x.permute(*d))(u, 0, 2, 1)
        Kf = (lambda x, *a, **k: torch.fft.rfft(x.float(), *a, **k))(K, L2)
        Uf = (lambda x, *a, **k: torch.fft.rfft(x.float(), *a, **k))(u_t, L2)
        y = (lambda x, *a, **k: torch.fft.irfft(x, *a, **k).to(torch.bfloat16))(Uf * Kf[None, :, :], L2)[:, :, :L]
        y = (lambda x, *d: x.permute(*d))(y, 0, 2, 1)
        return y + u * D_skip[None, None, :]

    def _B_ref(x, w1, w3, w2):
        gate = torch.einsum('bsd,df->bsf', x, w1)
        up = torch.einsum('bsd,df->bsf', x, w3)
        h = _silu(gate) * up
        out = torch.einsum('bsf,fd->bsd', h, w2)
        return out
    x = A_u
    mod = (_silu(c) @ w_mod).reshape(c.shape[0], 6, 1, -1)
    sa, ca, ga, sb, cb, gb = (mod[:, 0].clone(), mod[:, 1].clone(), mod[:, 2].clone(), mod[:, 3].clone(), mod[:, 4].clone(), mod[:, 5].clone())
    h = _layernorm(x, axis=-1) * (1 + ca) + sa
    x = x + ga * _A_ref(h, A_log_A_real, A_A_imag, A_C_real, A_C_imag, A_log_dt, A_D_skip)
    h = _layernorm(x, axis=-1) * (1 + cb) + sb
    x = x + gb * _B_ref(h, B_w1, B_w3, B_w2)
    return x
```

```asm
; @launch kernel=front_kernel grid=(416,1,1) block=(256,1,1) lds=74560
; @launch kernel=gemm1_kernel grid=(256,1,1) block=(512,1,1) lds=145408
.amdgcn_target "amdgcn-amd-amdhsa--gfx950"
.text
.globl front_kernel
.p2align 8
.type front_kernel,@function
front_kernel:
    s_cmp_ge_u32 s2, 416
    s_cbranch_scc1 f_pend
    s_cmp_lt_u32 s2, 8
    s_cbranch_scc1 f_ipf
    s_sub_u32 s2, s2, 8
    s_load_dwordx2 s[4:5], s[0:1], 120
    s_load_dwordx2 s[28:29], s[0:1], 112
    v_and_b32 v1, 63, v0
    v_lshrrev_b32 v2, 6, v0
    s_cmp_lt_u32 s2, 248
    v_readfirstlane_b32 s32, v2
    s_cbranch_scc1 f_prod
    s_setprio 2
    s_load_dwordx2 s[8:9], s[0:1], 8
    s_load_dwordx2 s[12:13], s[0:1], 16
    s_load_dwordx2 s[16:17], s[0:1], 24
    s_load_dwordx2 s[20:21], s[0:1], 32
    s_load_dwordx2 s[24:25], s[0:1], 40
    s_load_dwordx2 s[6:7], s[0:1], 48
    s_sub_u32 s2, s2, 248
    s_lshl_b32 s3, s2, 2
    s_add_u32 s3, s3, s32
    s_lshl_b32 s33, s3, 8
    s_lshl_b32 s3, s3, 1
    v_lshlrev_b32 v4, 2, v1
    v_mov_b32 v5, 0
    s_lshl_b32 s34, s2, 3
    s_waitcnt lgkmcnt(0)
    s_mov_b32 s10, 163840
    s_mov_b32 s11, 0x00020000
    s_mov_b32 s14, 163840
    s_mov_b32 s15, 0x00020000
    s_mov_b32 s18, 163840
    s_mov_b32 s19, 0x00020000
    s_mov_b32 s22, 163840
    s_mov_b32 s23, 0x00020000
    s_mov_b32 s26, 1280
    s_mov_b32 s27, 0x00020000
    s_mov_b32 s30, 256
    s_mov_b32 s31, 0x00020000
    buffer_load_ushort v10, v5, s[24:27], s3 offen
    buffer_load_dword v11, v4, s[8:11], s33 offen
    buffer_load_dword v12, v4, s[12:15], s33 offen
    buffer_load_dword v13, v4, s[16:19], s33 offen
    buffer_load_dword v14, v4, s[20:23], s33 offen
    s_add_u32 s6, s6, s34
    s_addc_u32 s7, s7, 0
    s_load_dwordx2 s[36:37], s[6:7], 0
    s_add_u32 s40, s4, 1048576
    s_addc_u32 s41, s5, 0
    s_mov_b32 s42, 2621440
    s_mov_b32 s43, 0x00020000
    s_add_u32 s44, s4, 65536
    s_addc_u32 s45, s5, 0
    s_mov_b32 s46, 16384
    s_mov_b32 s47, 0x00020000
    s_add_u32 s48, s4, 0
    s_addc_u32 s49, s5, 0
    s_mov_b32 s50, 30720
    s_mov_b32 s51, 0x00020000
    s_add_u32 s52, s4, 1048576
    s_addc_u32 s53, s5, 0
    s_mov_b32 s54, 2621440
    s_mov_b32 s55, 0x00020000
    s_mul_i32 s35, s32, 14416
    s_add_u32 s35, s35, 16896
    v_add_u32 v6, s35, v4
    v_and_b32 v8, 31, v1
    v_lshrrev_b32 v9, 5, v1
    v_min_u32 v60, 20, v8
    v_mul_u32_u24 v60, 272, v60
    v_mul_u32_u24 v61, 272, v8
    v_lshl_add_u32 v7, v9, 4, s35
    v_add_u32 v60, v60, v7
    v_add_u32 v61, v61, v7
    v_lshl_add_u32 v62, v1, 4, s35
    s_mul_i32 s38, s32, 4224
    v_lshl_add_u32 v63, v1, 4, s38
    v_lshl_add_u32 v7, v8, 2, s38
    ds_write_b32 v7, v5
    v_lshl_add_u32 v7, v8, 4, s35
    v_lshl_add_u32 v48, v9, 3, v7
    s_movk_i32 s39, 512
    v_mad_u32_u24 v49, v9, s39, v7
    s_movk_i32 s39, 516
    v_mad_u32_u24 v50, v9, s39, v7
    s_movk_i32 s39, 1016
    v_mad_u32_u24 v51, v9, s39, v7
    s_movk_i32 s39, 1020
    v_mad_u32_u24 v52, v9, s39, v7
    s_movk_i32 s39, 2048
    v_mad_u32_u24 v53, v9, s39, v7
    s_movk_i32 s39, 1536
    v_mad_u32_u24 v54, v9, s39, v7
    s_movk_i32 s39, 1024
    v_mad_u32_u24 v55, v9, s39, v7
    s_movk_i32 s39, 512
    v_mad_u32_u24 v56, v9, s39, v7
    v_mov_b32 v57, 0x03020100
    v_mov_b32 v58, 0x03020100
    s_mov_b32 exec_lo, 0
    v_mov_b32 v57, 0x01000100
    v_mov_b32 v58, 0x05040100
    s_mov_b32 exec_lo, -1
    v_and_b32 v59, 1, v1
    v_mul_u32_u24 v59, 0x404, v59
    v_add_u32 v59, 0x05040100, v59
    s_mov_b32 s56, 0x01000100
    s_mov_b32 s57, 0x05040100
    s_waitcnt vmcnt(0)
    v_lshlrev_b32 v10, 16, v10
    v_mul_f32 v10, 0x3fb8aa3b, v10
    v_exp_f32 v10, v10
    s_nop 0
    v_cvt_pk_bf16_f32 v10, v10, v10
    v_lshlrev_b32 v10, 16, v10
    v_lshlrev_b32 v15, 16, v11
    v_lshlrev_b32 v9, 16, v12
    v_lshlrev_b32 v32, 16, v13
    v_lshlrev_b32 v33, 16, v14
    v_mul_f32 v15, 0x3fb8aa3b, v15
    v_exp_f32 v15, v15
    v_mul_f32 v9, v9, v10
    v_add_f32 v8, v10, v10
    v_cvt_pk_bf16_f32 v15, v15, v15
    v_lshlrev_b32 v15, 16, v15
    v_mul_f32 v15, v15, v10
    v_mul_f32 v9, 0.15915494, v9
    v_mul_f32 v15, 0xbfb8aa3b, v15
    v_mul_f32 v32, v32, v8
    v_mul_f32 v33, v33, -v8
    v_mul_f32 v22, 0x41000000, v15
    v_mul_f32 v23, 0x41000000, v9
    v_exp_f32 v22, v22
    v_fract_f32 v23, v23
    v_cos_f32 v16, v23
    v_sin_f32 v17, v23
    s_nop 0
    v_mul_f32 v16, v16, v22
    v_mul_f32 v17, v17, v22
    v_exp_f32 v22, v15
    v_fract_f32 v23, v9
    v_cos_f32 v18, v23
    v_sin_f32 v19, v23
    s_nop 0
    v_mul_f32 v18, v18, v22
    v_mul_f32 v19, v19, v22
    v_mul_f32 v22, 0x43800000, v15
    v_mul_f32 v23, 0x43800000, v9
    v_exp_f32 v22, v22
    v_fract_f32 v23, v23
    v_cos_f32 v20, v23
    v_sin_f32 v21, v23
    s_nop 0
    v_mul_f32 v20, v20, v22
    v_mul_f32 v21, v21, v22
    v_mov_b32 v26, 0x3f80
    v_cvt_pk_bf16_f32 v27, v32, v33
    ds_write_b32 v6, v26
    ds_write_b32 v6, v27 offset:8704
    v_cvt_pk_bf16_f32 v26, v16, v17
    ds_write_b32 v6, v26 offset:272
    v_pk_mul_f32 v[22:23], v[16:17], v[16:17] op_sel:[1,1] op_sel_hi:[1,0] neg_lo:[0,1]
    v_pk_mul_f32 v[24:25], v[32:33], v[18:19] op_sel:[1,1] op_sel_hi:[1,0]
    v_pk_fma_f32 v[28:29], v[16:17], v[16:17], v[22:23] op_sel_hi:[0,1,1]
    v_pk_fma_f32 v[34:35], v[32:33], v[18:19], v[24:25] op_sel_hi:[0,1,1] neg_hi:[0,1,0]
    v_cvt_pk_bf16_f32 v26, v28, v29
    v_cvt_pk_bf16_f32 v27, v34, v35
    ds_write_b32 v6, v26 offset:544
    ds_write_b32 v6, v27 offset:8976
    v_pk_mul_f32 v[22:23], v[28:29], v[16:17] op_sel:[1,1] op_sel_hi:[1,0] neg_lo:[0,1]
    v_pk_mul_f32 v[24:25], v[34:35], v[18:19] op_sel:[1,1] op_sel_hi:[1,0]
    v_pk_fma_f32 v[30:31], v[28:29], v[16:17], v[22:23] op_sel_hi:[0,1,1]
    v_pk_fma_f32 v[36:37], v[34:35], v[18:19], v[24:25] op_sel_hi:[0,1,1] neg_hi:[0,1,0]
    v_cvt_pk_bf16_f32 v26, v30, v31
    v_cvt_pk_bf16_f32 v27, v36, v37
    ds_write_b32 v6, v26 offset:816
    ds_write_b32 v6, v27 offset:9248
    v_pk_mul_f32 v[22:23], v[30:31], v[16:17] op_sel:[1,1] op_sel_hi:[1,0] neg_lo:[0,1]
    v_pk_mul_f32 v[24:25], v[36:37], v[18:19] op_sel:[1,1] op_sel_hi:[1,0]
    v_pk_fma_f32 v[28:29], v[30:31], v[16:17], v[22:23] op_sel_hi:[0,1,1]
    v_pk_fma_f32 v[38:39], v[36:37], v[18:19], v[24:25] op_sel_hi:[0,1,1] neg_hi:[0,1,0]
    v_cvt_pk_bf16_f32 v26, v28, v29
    v_cvt_pk_bf16_f32 v27, v38, v39
    ds_write_b32 v6, v26 offset:1088
    ds_write_b32 v6, v27 offset:9520
    v_pk_mul_f32 v[22:23], v[28:29], v[16:17] op_sel:[1,1] op_sel_hi:[1,0] neg_lo:[0,1]
    v_pk_mul_f32 v[24:25], v[38:39], v[18:19] op_sel:[1,1] op_sel_hi:[1,0]
    v_pk_fma_f32 v[30:31], v[28:29], v[16:17], v[22:23] op_sel_hi:[0,1,1]
    v_pk_fma_f32 v[40:41], v[38:39], v[18:19], v[24:25] op_sel_hi:[0,1,1] neg_hi:[0,1,0]
    v_cvt_pk_bf16_f32 v26, v30, v31
    v_cvt_pk_bf16_f32 v27, v40, v41
    ds_write_b32 v6, v26 offset:1360
    ds_write_b32 v6, v27 offset:9792
    v_pk_mul_f32 v[22:23], v[30:31], v[16:17] op_sel:[1,1] op_sel_hi:[1,0] neg_lo:[0,1]
    v_pk_mul_f32 v[24:25], v[40:41], v[18:19] op_sel:[1,1] op_sel_hi:[1,0]
    v_pk_fma_f32 v[28:29], v[30:31], v[16:17], v[22:23] op_sel_hi:[0,1,1]
    v_pk_fma_f32 v[42:43], v[40:41], v[18:19], v[24:25] op_sel_hi:[0,1,1] neg_hi:[0,1,0]
    v_cvt_pk_bf16_f32 v26, v28, v29
    v_cvt_pk_bf16_f32 v27, v42, v43
    ds_write_b32 v6, v26 offset:1632
    ds_write_b32 v6, v27 offset:10064
    v_pk_mul_f32 v[22:23], v[28:29], v[16:17] op_sel:[1,1] op_sel_hi:[1,0] neg_lo:[0,1]
    v_pk_mul_f32 v[24:25], v[42:43], v[18:19] op_sel:[1,1] op_sel_hi:[1,0]
    v_pk_fma_f32 v[30:31], v[28:29], v[16:17], v[22:23] op_sel_hi:[0,1,1]
    v_pk_fma_f32 v[44:45], v[42:43], v[18:19], v[24:25] op_sel_hi:[0,1,1] neg_hi:[0,1,0]
    v_cvt_pk_bf16_f32 v26, v30, v31
    v_cvt_pk_bf16_f32 v27, v44, v45
    ds_write_b32 v6, v26 offset:1904
    ds_write_b32 v6, v27 offset:10336
    v_pk_mul_f32 v[22:23], v[30:31], v[16:17] op_sel:[1,1] op_sel_hi:[1,0] neg_lo:[0,1]
    v_pk_mul_f32 v[24:25], v[44:45], v[18:19] op_sel:[1,1] op_sel_hi:[1,0]
    v_pk_fma_f32 v[28:29], v[30:31], v[16:17], v[22:23] op_sel_hi:[0,1,1]
    v_pk_fma_f32 v[46:47], v[44:45], v[18:19], v[24:25] op_sel_hi:[0,1,1] neg_hi:[0,1,0]
    v_cvt_pk_bf16_f32 v26, v28, v29
    v_cvt_pk_bf16_f32 v27, v46, v47
    ds_write_b32 v6, v26 offset:2176
    ds_write_b32 v6, v27 offset:10608
    v_pk_mul_f32 v[22:23], v[28:29], v[16:17] op_sel:[1,1] op_sel_hi:[1,0] neg_lo:[0,1]
    v_pk_mul_f32 v[24:25], v[32:33], v[20:21] op_sel:[1,1] op_sel_hi:[1,0]
    v_pk_fma_f32 v[30:31], v[28:29], v[16:17], v[22:23] op_sel_hi:[0,1,1]
    v_pk_fma_f32 v[32:33], v[32:33], v[20:21], v[24:25] op_sel_hi:[0,1,1] neg_hi:[0,1,0]
    v_cvt_pk_bf16_f32 v26, v30, v31
    v_cvt_pk_bf16_f32 v27, v32, v33
    ds_write_b32 v6, v26 offset:2448
    ds_write_b32 v6, v27 offset:10880
    v_pk_mul_f32 v[22:23], v[30:31], v[16:17] op_sel:[1,1] op_sel_hi:[1,0] neg_lo:[0,1]
    v_pk_mul_f32 v[24:25], v[36:37], v[20:21] op_sel:[1,1] op_sel_hi:[1,0]
    v_pk_fma_f32 v[28:29], v[30:31], v[16:17], v[22:23] op_sel_hi:[0,1,1]
    v_pk_fma_f32 v[36:37], v[36:37], v[20:21], v[24:25] op_sel_hi:[0,1,1] neg_hi:[0,1,0]
    v_cvt_pk_bf16_f32 v26, v28, v29
    v_cvt_pk_bf16_f32 v27, v36, v37
    ds_write_b32 v6, v26 offset:2720
    ds_write_b32 v6, v27 offset:11152
    v_pk_mul_f32 v[22:23], v[28:29], v[16:17] op_sel:[1,1] op_sel_hi:[1,0] neg_lo:[0,1]
    v_pk_mul_f32 v[24:25], v[40:41], v[20:21] op_sel:[1,1] op_sel_hi:[1,0]
    v_pk_fma_f32 v[30:31], v[28:29], v[16:17], v[22:23] op_sel_hi:[0,1,1]
    v_pk_fma_f32 v[40:41], v[40:41], v[20:21], v[24:25] op_sel_hi:[0,1,1] neg_hi:[0,1,0]
    v_cvt_pk_bf16_f32 v26, v30, v31
    v_cvt_pk_bf16_f32 v27, v40, v41
    ds_write_b32 v6, v26 offset:2992
    ds_write_b32 v6, v27 offset:11424
    v_pk_mul_f32 v[22:23], v[30:31], v[16:17] op_sel:[1,1] op_sel_hi:[1,0] neg_lo:[0,1]
    v_pk_mul_f32 v[24:25], v[44:45], v[20:21] op_sel:[1,1] op_sel_hi:[1,0]
    v_pk_fma_f32 v[28:29], v[30:31], v[16:17], v[22:23] op_sel_hi:[0,1,1]
    v_pk_fma_f32 v[44:45], v[44:45], v[20:21], v[24:25] op_sel_hi:[0,1,1] neg_hi:[0,1,0]
    v_cvt_pk_bf16_f32 v26, v28, v29
    v_cvt_pk_bf16_f32 v27, v44, v45
    ds_write_b32 v6, v26 offset:3264
    ds_write_b32 v6, v27 offset:11696
    v_pk_mul_f32 v[22:23], v[28:29], v[16:17] op_sel:[1,1] op_sel_hi:[1,0] neg_lo:[0,1]
    v_pk_mul_f32 v[24:25], v[32:33], v[20:21] op_sel:[1,1] op_sel_hi:[1,0]
    v_pk_fma_f32 v[30:31], v[28:29], v[16:17], v[22:23] op_sel_hi:[0,1,1]
    v_pk_fma_f32 v[32:33], v[32:33], v[20:21], v[24:25] op_sel_hi:[0,1,1] neg_hi:[0,1,0]
    v_cvt_pk_bf16_f32 v26, v30, v31
    v_cvt_pk_bf16_f32 v27, v32, v33
    ds_write_b32 v6, v26 offset:3536
    ds_write_b32 v6, v27 offset:11968
    v_pk_mul_f32 v[22:23], v[30:31], v[16:17] op_sel:[1,1] op_sel_hi:[1,0] neg_lo:[0,1]
    v_pk_mul_f32 v[24:25], v[40:41], v[20:21] op_sel:[1,1] op_sel_hi:[1,0]
    v_pk_fma_f32 v[28:29], v[30:31], v[16:17], v[22:23] op_sel_hi:[0,1,1]
    v_pk_fma_f32 v[40:41], v[40:41], v[20:21], v[24:25] op_sel_hi:[0,1,1] neg_hi:[0,1,0]
    v_cvt_pk_bf16_f32 v26, v28, v29
    v_cvt_pk_bf16_f32 v27, v40, v41
    ds_write_b32 v6, v26 offset:3808
    ds_write_b32 v6, v27 offset:12240
    v_pk_mul_f32 v[22:23], v[28:29], v[16:17] op_sel:[1,1] op_sel_hi:[1,0] neg_lo:[0,1]
    v_pk_mul_f32 v[24:25], v[32:33], v[20:21] op_sel:[1,1] op_sel_hi:[1,0]
    v_pk_fma_f32 v[30:31], v[28:29], v[16:17], v[22:23] op_sel_hi:[0,1,1]
    v_pk_fma_f32 v[32:33], v[32:33], v[20:21], v[24:25] op_sel_hi:[0,1,1] neg_hi:[0,1,0]
    v_cvt_pk_bf16_f32 v26, v30, v31
    v_cvt_pk_bf16_f32 v27, v32, v33
    ds_write_b32 v6, v26 offset:4080
    ds_write_b32 v6, v27 offset:12512
    v_pk_mul_f32 v[22:23], v[30:31], v[16:17] op_sel:[1,1] op_sel_hi:[1,0] neg_lo:[0,1]
    v_pk_mul_f32 v[24:25], v[40:41], v[20:21] op_sel:[1,1] op_sel_hi:[1,0]
    v_pk_fma_f32 v[28:29], v[30:31], v[16:17], v[22:23] op_sel_hi:[0,1,1]
    v_pk_fma_f32 v[40:41], v[40:41], v[20:21], v[24:25] op_sel_hi:[0,1,1] neg_hi:[0,1,0]
    v_cvt_pk_bf16_f32 v26, v28, v29
    v_cvt_pk_bf16_f32 v27, v40, v41
    ds_write_b32 v6, v26 offset:4352
    ds_write_b32 v6, v27 offset:12784
    v_pk_mul_f32 v[22:23], v[28:29], v[16:17] op_sel:[1,1] op_sel_hi:[1,0] neg_lo:[0,1]
    v_pk_mul_f32 v[24:25], v[32:33], v[20:21] op_sel:[1,1] op_sel_hi:[1,0]
    v_pk_fma_f32 v[30:31], v[28:29], v[16:17], v[22:23] op_sel_hi:[0,1,1]
    v_pk_fma_f32 v[32:33], v[32:33], v[20:21], v[24:25] op_sel_hi:[0,1,1] neg_hi:[0,1,0]
    v_cvt_pk_bf16_f32 v26, v30, v31
    v_cvt_pk_bf16_f32 v27, v32, v33
    ds_write_b32 v6, v26 offset:4624
    ds_write_b32 v6, v27 offset:13056
    v_pk_mul_f32 v[22:23], v[30:31], v[16:17] op_sel:[1,1] op_sel_hi:[1,0] neg_lo:[0,1]
    v_pk_mul_f32 v[24:25], v[32:33], v[20:21] op_sel:[1,1] op_sel_hi:[1,0]
    v_pk_fma_f32 v[28:29], v[30:31], v[16:17], v[22:23] op_sel_hi:[0,1,1]
    v_pk_fma_f32 v[32:33], v[32:33], v[20:21], v[24:25] op_sel_hi:[0,1,1] neg_hi:[0,1,0]
    v_cvt_pk_bf16_f32 v26, v28, v29
    v_cvt_pk_bf16_f32 v27, v32, v33
    ds_write_b32 v6, v26 offset:4896
    ds_write_b32 v6, v27 offset:13328
    v_pk_mul_f32 v[22:23], v[28:29], v[16:17] op_sel:[1,1] op_sel_hi:[1,0] neg_lo:[0,1]
    v_pk_mul_f32 v[24:25], v[32:33], v[20:21] op_sel:[1,1] op_sel_hi:[1,0]
    v_pk_fma_f32 v[30:31], v[28:29], v[16:17], v[22:23] op_sel_hi:[0,1,1]
    v_pk_fma_f32 v[32:33], v[32:33], v[20:21], v[24:25] op_sel_hi:[0,1,1] neg_hi:[0,1,0]
    v_cvt_pk_bf16_f32 v26, v30, v31
    v_cvt_pk_bf16_f32 v27, v32, v33
    ds_write_b32 v6, v26 offset:5168
    ds_write_b32 v6, v27 offset:13600
    v_pk_mul_f32 v[22:23], v[30:31], v[16:17] op_sel:[1,1] op_sel_hi:[1,0] neg_lo:[0,1]
    v_pk_mul_f32 v[24:25], v[32:33], v[20:21] op_sel:[1,1] op_sel_hi:[1,0]
    v_pk_fma_f32 v[28:29], v[30:31], v[16:17], v[22:23] op_sel_hi:[0,1,1]
    v_pk_fma_f32 v[32:33], v[32:33], v[20:21], v[24:25] op_sel_hi:[0,1,1] neg_hi:[0,1,0]
    v_cvt_pk_bf16_f32 v26, v28, v29
    v_cvt_pk_bf16_f32 v27, v32, v33
    ds_write_b32 v6, v26 offset:5440
    ds_write_b32 v6, v27 offset:13872
    v_pk_mul_f32 v[22:23], v[28:29], v[16:17] op_sel:[1,1] op_sel_hi:[1,0] neg_lo:[0,1]
    v_pk_mul_f32 v[24:25], v[32:33], v[20:21] op_sel:[1,1] op_sel_hi:[1,0]
    v_pk_fma_f32 v[30:31], v[28:29], v[16:17], v[22:23] op_sel_hi:[0,1,1]
    v_pk_fma_f32 v[32:33], v[32:33], v[20:21], v[24:25] op_sel_hi:[0,1,1] neg_hi:[0,1,0]
    v_cvt_pk_bf16_f32 v26, v30, v31
    v_cvt_pk_bf16_f32 v27, v32, v33
    ds_write_b32 v6, v26 offset:5712
    ds_write_b32 v6, v27 offset:14144
    v_pk_mul_f32 v[22:23], v[30:31], v[16:17] op_sel:[1,1] op_sel_hi:[1,0] neg_lo:[0,1]
    v_pk_fma_f32 v[28:29], v[30:31], v[16:17], v[22:23] op_sel_hi:[0,1,1]
    v_cvt_pk_bf16_f32 v26, v28, v29
    ds_write_b32 v6, v26 offset:5984
    v_pk_mul_f32 v[22:23], v[28:29], v[16:17] op_sel:[1,1] op_sel_hi:[1,0] neg_lo:[0,1]
    v_pk_fma_f32 v[30:31], v[28:29], v[16:17], v[22:23] op_sel_hi:[0,1,1]
    v_cvt_pk_bf16_f32 v26, v30, v31
    ds_write_b32 v6, v26 offset:6256
    v_pk_mul_f32 v[22:23], v[30:31], v[16:17] op_sel:[1,1] op_sel_hi:[1,0] neg_lo:[0,1]
    v_pk_fma_f32 v[28:29], v[30:31], v[16:17], v[22:23] op_sel_hi:[0,1,1]
    v_cvt_pk_bf16_f32 v26, v28, v29
    ds_write_b32 v6, v26 offset:6528
    v_pk_mul_f32 v[22:23], v[28:29], v[16:17] op_sel:[1,1] op_sel_hi:[1,0] neg_lo:[0,1]
    v_pk_fma_f32 v[30:31], v[28:29], v[16:17], v[22:23] op_sel_hi:[0,1,1]
    v_cvt_pk_bf16_f32 v26, v30, v31
    ds_write_b32 v6, v26 offset:6800
    v_pk_mul_f32 v[22:23], v[30:31], v[16:17] op_sel:[1,1] op_sel_hi:[1,0] neg_lo:[0,1]
    v_pk_fma_f32 v[28:29], v[30:31], v[16:17], v[22:23] op_sel_hi:[0,1,1]
    v_cvt_pk_bf16_f32 v26, v28, v29
    ds_write_b32 v6, v26 offset:7072
    v_pk_mul_f32 v[22:23], v[28:29], v[16:17] op_sel:[1,1] op_sel_hi:[1,0] neg_lo:[0,1]
    v_pk_fma_f32 v[30:31], v[28:29], v[16:17], v[22:23] op_sel_hi:[0,1,1]
    v_cvt_pk_bf16_f32 v26, v30, v31
    ds_write_b32 v6, v26 offset:7344
    v_pk_mul_f32 v[22:23], v[30:31], v[16:17] op_sel:[1,1] op_sel_hi:[1,0] neg_lo:[0,1]
    v_pk_fma_f32 v[28:29], v[30:31], v[16:17], v[22:23] op_sel_hi:[0,1,1]
    v_cvt_pk_bf16_f32 v26, v28, v29
    ds_write_b32 v6, v26 offset:7616
    v_pk_mul_f32 v[22:23], v[28:29], v[16:17] op_sel:[1,1] op_sel_hi:[1,0] neg_lo:[0,1]
    v_pk_fma_f32 v[30:31], v[28:29], v[16:17], v[22:23] op_sel_hi:[0,1,1]
    v_cvt_pk_bf16_f32 v26, v30, v31
    ds_write_b32 v6, v26 offset:7888
    v_pk_mul_f32 v[22:23], v[30:31], v[16:17] op_sel:[1,1] op_sel_hi:[1,0] neg_lo:[0,1]
    v_pk_fma_f32 v[28:29], v[30:31], v[16:17], v[22:23] op_sel_hi:[0,1,1]
    v_cvt_pk_bf16_f32 v26, v28, v29
    ds_write_b32 v6, v26 offset:8160
    v_pk_mul_f32 v[22:23], v[28:29], v[16:17] op_sel:[1,1] op_sel_hi:[1,0] neg_lo:[0,1]
    v_pk_fma_f32 v[30:31], v[28:29], v[16:17], v[22:23] op_sel_hi:[0,1,1]
    v_cvt_pk_bf16_f32 v26, v30, v31
    ds_write_b32 v6, v26 offset:8432
    ds_read_b128 v[64:67], v60 offset:8704
    ds_read_b128 v[96:99], v61 offset:0
    ds_read_b128 v[68:71], v60 offset:8736
    ds_read_b128 v[100:103], v61 offset:32
    ds_read_b128 v[72:75], v60 offset:8768
    ds_read_b128 v[104:107], v61 offset:64
    ds_read_b128 v[76:79], v60 offset:8800
    ds_read_b128 v[108:111], v61 offset:96
    ds_read_b128 v[80:83], v60 offset:8832
    ds_read_b128 v[112:115], v61 offset:128
    ds_read_b128 v[84:87], v60 offset:8864
    ds_read_b128 v[116:119], v61 offset:160
    ds_read_b128 v[88:91], v60 offset:8896
    ds_read_b128 v[120:123], v61 offset:192
    ds_read_b128 v[92:95], v60 offset:8928
    ds_read_b128 v[124:127], v61 offset:224
    v_and_b32 v15, 0xffff0000, v11
    v_and_b32 v9, 0xffff0000, v12
    v_and_b32 v32, 0xffff0000, v13
    v_and_b32 v33, 0xffff0000, v14
    v_mul_f32 v15, 0x3fb8aa3b, v15
    v_exp_f32 v15, v15
    v_mul_f32 v9, v9, v10
    v_add_f32 v8, v10, v10
    v_cvt_pk_bf16_f32 v15, v15, v15
    v_lshlrev_b32 v15, 16, v15
    v_mul_f32 v15, v15, v10
    v_mul_f32 v9, 0.15915494, v9
    v_mul_f32 v15, 0xbfb8aa3b, v15
    v_mul_f32 v32, v32, v8
    v_mul_f32 v33, v33, -v8
    v_mul_f32 v22, 0x41000000, v15
    v_mul_f32 v23, 0x41000000, v9
    v_exp_f32 v22, v22
    v_fract_f32 v23, v23
    v_cos_f32 v16, v23
    v_sin_f32 v17, v23
    s_nop 0
    v_mul_f32 v16, v16, v22
    v_mul_f32 v17, v17, v22
    v_exp_f32 v22, v15
    v_fract_f32 v23, v9
    v_cos_f32 v18, v23
    v_sin_f32 v19, v23
    s_nop 0
    v_mul_f32 v18, v18, v22
    v_mul_f32 v19, v19, v22
    v_mul_f32 v22, 0x43800000, v15
    v_mul_f32 v23, 0x43800000, v9
    v_exp_f32 v22, v22
    v_fract_f32 v23, v23
    v_cos_f32 v20, v23
    v_sin_f32 v21, v23
    s_nop 0
    v_mul_f32 v20, v20, v22
    v_mul_f32 v21, v21, v22
    s_waitcnt lgkmcnt(0)
    v_mfma_f32_32x32x16_bf16 v[128:143], v[64:67], v[96:99], 0
    v_mfma_f32_32x32x16_bf16 v[128:143], v[68:71], v[100:103], v[128:143]
    v_mfma_f32_32x32x16_bf16 v[128:143], v[72:75], v[104:107], v[128:143]
    v_mfma_f32_32x32x16_bf16 v[128:143], v[76:79], v[108:111], v[128:143]
    v_mfma_f32_32x32x16_bf16 v[128:143], v[80:83], v[112:115], v[128:143]
    v_mfma_f32_32x32x16_bf16 v[128:143], v[84:87], v[116:119], v[128:143]
    v_mfma_f32_32x32x16_bf16 v[128:143], v[88:91], v[120:123], v[128:143]
    v_mfma_f32_32x32x16_bf16 v[128:143], v[92:95], v[124:127], v[128:143]
    v_mov_b32 v26, 0x3f80
    v_cvt_pk_bf16_f32 v27, v32, v33
    ds_write_b32 v6, v26
    ds_write_b32 v6, v27 offset:8704
    v_cvt_pk_bf16_f32 v26, v16, v17
    ds_write_b32 v6, v26 offset:272
    v_pk_mul_f32 v[22:23], v[16:17], v[16:17] op_sel:[1,1] op_sel_hi:[1,0] neg_lo:[0,1]
    v_pk_mul_f32 v[24:25], v[32:33], v[18:19] op_sel:[1,1] op_sel_hi:[1,0]
    v_pk_fma_f32 v[28:29], v[16:17], v[16:17], v[22:23] op_sel_hi:[0,1,1]
    v_pk_fma_f32 v[34:35], v[32:33], v[18:19], v[24:25] op_sel_hi:[0,1,1] neg_hi:[0,1,0]
    v_cvt_pk_bf16_f32 v26, v28, v29
    v_cvt_pk_bf16_f32 v27, v34, v35
    ds_write_b32 v6, v26 offset:544
    ds_write_b32 v6, v27 offset:8976
    v_pk_mul_f32 v[22:23], v[28:29], v[16:17] op_sel:[1,1] op_sel_hi:[1,0] neg_lo:[0,1]
    v_pk_mul_f32 v[24:25], v[34:35], v[18:19] op_sel:[1,1] op_sel_hi:[1,0]
    v_pk_fma_f32 v[30:31], v[28:29], v[16:17], v[22:23] op_sel_hi:[0,1,1]
    v_pk_fma_f32 v[36:37], v[34:35], v[18:19], v[24:25] op_sel_hi:[0,1,1] neg_hi:[0,1,0]
    v_cvt_pk_bf16_f32 v26, v30, v31
    v_cvt_pk_bf16_f32 v27, v36, v37
    ds_write_b32 v6, v26 offset:816
    ds_write_b32 v6, v27 offset:9248
    v_pk_mul_f32 v[22:23], v[30:31], v[16:17] op_sel:[1,1] op_sel_hi:[1,0] neg_lo:[0,1]
    v_pk_mul_f32 v[24:25], v[36:37], v[18:19] op_sel:[1,1] op_sel_hi:[1,0]
    v_pk_fma_f32 v[28:29], v[30:31], v[16:17], v[22:23] op_sel_hi:[0,1,1]
    v_pk_fma_f32 v[38:39], v[36:37], v[18:19], v[24:25] op_sel_hi:[0,1,1] neg_hi:[0,1,0]
    v_cvt_pk_bf16_f32 v26, v28, v29
    v_cvt_pk_bf16_f32 v27, v38, v39
    ds_write_b32 v6, v26 offset:1088
    ds_write_b32 v6, v27 offset:9520
    v_pk_mul_f32 v[22:23], v[28:29], v[16:17] op_sel:[1,1] op_sel_hi:[1,0] neg_lo:[0,1]
    v_pk_mul_f32 v[24:25], v[38:39], v[18:19] op_sel:[1,1] op_sel_hi:[1,0]
    v_pk_fma_f32 v[30:31], v[28:29], v[16:17], v[22:23] op_sel_hi:[0,1,1]
    v_pk_fma_f32 v[40:41], v[38:39], v[18:19], v[24:25] op_sel_hi:[0,1,1] neg_hi:[0,1,0]
    v_cvt_pk_bf16_f32 v26, v30, v31
    v_cvt_pk_bf16_f32 v27, v40, v41
    ds_write_b32 v6, v26 offset:1360
    ds_write_b32 v6, v27 offset:9792
    v_pk_mul_f32 v[22:23], v[30:31], v[16:17] op_sel:[1,1] op_sel_hi:[1,0] neg_lo:[0,1]
    v_pk_mul_f32 v[24:25], v[40:41], v[18:19] op_sel:[1,1] op_sel_hi:[1,0]
    v_pk_fma_f32 v[28:29], v[30:31], v[16:17], v[22:23] op_sel_hi:[0,1,1]
    v_pk_fma_f32 v[42:43], v[40:41], v[18:19], v[24:25] op_sel_hi:[0,1,1] neg_hi:[0,1,0]
    v_cvt_pk_bf16_f32 v26, v28, v29
    v_cvt_pk_bf16_f32 v27, v42, v43
    ds_write_b32 v6, v26 offset:1632
    ds_write_b32 v6, v27 offset:10064
    v_pk_mul_f32 v[22:23], v[28:29], v[16:17] op_sel:[1,1] op_sel_hi:[1,0] neg_lo:[0,1]
    v_pk_mul_f32 v[24:25], v[42:43], v[18:19] op_sel:[1,1] op_sel_hi:[1,0]
    v_pk_fma_f32 v[30:31], v[28:29], v[16:17], v[22:23] op_sel_hi:[0,1,1]
    v_pk_fma_f32 v[44:45], v[42:43], v[18:19], v[24:25] op_sel_hi:[0,1,1] neg_hi:[0,1,0]
    v_cvt_pk_bf16_f32 v26, v30, v31
    v_cvt_pk_bf16_f32 v27, v44, v45
    ds_write_b32 v6, v26 offset:1904
    ds_write_b32 v6, v27 offset:10336
    v_pk_mul_f32 v[22:23], v[30:31], v[16:17] op_sel:[1,1] op_sel_hi:[1,0] neg_lo:[0,1]
    v_pk_mul_f32 v[24:25], v[44:45], v[18:19] op_sel:[1,1] op_sel_hi:[1,0]
    v_pk_fma_f32 v[28:29], v[30:31], v[16:17], v[22:23] op_sel_hi:[0,1,1]
    v_pk_fma_f32 v[46:47], v[44:45], v[18:19], v[24:25] op_sel_hi:[0,1,1] neg_hi:[0,1,0]
    v_cvt_pk_bf16_f32 v26, v28, v29
    v_cvt_pk_bf16_f32 v27, v46, v47
    ds_write_b32 v6, v26 offset:2176
    ds_write_b32 v6, v27 offset:10608
    v_pk_mul_f32 v[22:23], v[28:29], v[16:17] op_sel:[1,1] op_sel_hi:[1,0] neg_lo:[0,1]
    v_pk_mul_f32 v[24:25], v[32:33], v[20:21] op_sel:[1,1] op_sel_hi:[1,0]
    v_pk_fma_f32 v[30:31], v[28:29], v[16:17], v[22:23] op_sel_hi:[0,1,1]
    v_pk_fma_f32 v[32:33], v[32:33], v[20:21], v[24:25] op_sel_hi:[0,1,1] neg_hi:[0,1,0]
    v_cvt_pk_bf16_f32 v26, v30, v31
    v_cvt_pk_bf16_f32 v27, v32, v33
    ds_write_b32 v6, v26 offset:2448
    ds_write_b32 v6, v27 offset:10880
    v_pk_mul_f32 v[22:23], v[30:31], v[16:17] op_sel:[1,1] op_sel_hi:[1,0] neg_lo:[0,1]
    v_pk_mul_f32 v[24:25], v[36:37], v[20:21] op_sel:[1,1] op_sel_hi:[1,0]
    v_pk_fma_f32 v[28:29], v[30:31], v[16:17], v[22:23] op_sel_hi:[0,1,1]
    v_pk_fma_f32 v[36:37], v[36:37], v[20:21], v[24:25] op_sel_hi:[0,1,1] neg_hi:[0,1,0]
    v_cvt_pk_bf16_f32 v26, v28, v29
    v_cvt_pk_bf16_f32 v27, v36, v37
    ds_write_b32 v6, v26 offset:2720
    ds_write_b32 v6, v27 offset:11152
    v_pk_mul_f32 v[22:23], v[28:29], v[16:17] op_sel:[1,1] op_sel_hi:[1,0] neg_lo:[0,1]
    v_pk_mul_f32 v[24:25], v[40:41], v[20:21] op_sel:[1,1] op_sel_hi:[1,0]
    v_pk_fma_f32 v[30:31], v[28:29], v[16:17], v[22:23] op_sel_hi:[0,1,1]
    v_pk_fma_f32 v[40:41], v[40:41], v[20:21], v[24:25] op_sel_hi:[0,1,1] neg_hi:[0,1,0]
    v_cvt_pk_bf16_f32 v26, v30, v31
    v_cvt_pk_bf16_f32 v27, v40, v41
    ds_write_b32 v6, v26 offset:2992
    ds_write_b32 v6, v27 offset:11424
    v_pk_mul_f32 v[22:23], v[30:31], v[16:17] op_sel:[1,1] op_sel_hi:[1,0] neg_lo:[0,1]
    v_pk_mul_f32 v[24:25], v[44:45], v[20:21] op_sel:[1,1] op_sel_hi:[1,0]
    v_pk_fma_f32 v[28:29], v[30:31], v[16:17], v[22:23] op_sel_hi:[0,1,1]
    v_pk_fma_f32 v[44:45], v[44:45], v[20:21], v[24:25] op_sel_hi:[0,1,1] neg_hi:[0,1,0]
    v_cvt_pk_bf16_f32 v26, v28, v29
    v_cvt_pk_bf16_f32 v27, v44, v45
    ds_write_b32 v6, v26 offset:3264
    ds_write_b32 v6, v27 offset:11696
    v_pk_mul_f32 v[22:23], v[28:29], v[16:17] op_sel:[1,1] op_sel_hi:[1,0] neg_lo:[0,1]
    v_pk_mul_f32 v[24:25], v[32:33], v[20:21] op_sel:[1,1] op_sel_hi:[1,0]
    v_pk_fma_f32 v[30:31], v[28:29], v[16:17], v[22:23] op_sel_hi:[0,1,1]
    v_pk_fma_f32 v[32:33], v[32:33], v[20:21], v[24:25] op_sel_hi:[0,1,1] neg_hi:[0,1,0]
    v_cvt_pk_bf16_f32 v26, v30, v31
    v_cvt_pk_bf16_f32 v27, v32, v33
    ds_write_b32 v6, v26 offset:3536
    ds_write_b32 v6, v27 offset:11968
    v_pk_mul_f32 v[22:23], v[30:31], v[16:17] op_sel:[1,1] op_sel_hi:[1,0] neg_lo:[0,1]
    v_pk_mul_f32 v[24:25], v[40:41], v[20:21] op_sel:[1,1] op_sel_hi:[1,0]
    v_pk_fma_f32 v[28:29], v[30:31], v[16:17], v[22:23] op_sel_hi:[0,1,1]
    v_pk_fma_f32 v[40:41], v[40:41], v[20:21], v[24:25] op_sel_hi:[0,1,1] neg_hi:[0,1,0]
    v_cvt_pk_bf16_f32 v26, v28, v29
    v_cvt_pk_bf16_f32 v27, v40, v41
    ds_write_b32 v6, v26 offset:3808
    ds_write_b32 v6, v27 offset:12240
    v_pk_mul_f32 v[22:23], v[28:29], v[16:17] op_sel:[1,1] op_sel_hi:[1,0] neg_lo:[0,1]
    v_pk_mul_f32 v[24:25], v[32:33], v[20:21] op_sel:[1,1] op_sel_hi:[1,0]
    v_pk_fma_f32 v[30:31], v[28:29], v[16:17], v[22:23] op_sel_hi:[0,1,1]
    v_pk_fma_f32 v[32:33], v[32:33], v[20:21], v[24:25] op_sel_hi:[0,1,1] neg_hi:[0,1,0]
    v_cvt_pk_bf16_f32 v26, v30, v31
    v_cvt_pk_bf16_f32 v27, v32, v33
    ds_write_b32 v6, v26 offset:4080
    ds_write_b32 v6, v27 offset:12512
    v_pk_mul_f32 v[22:23], v[30:31], v[16:17] op_sel:[1,1] op_sel_hi:[1,0] neg_lo:[0,1]
    v_pk_mul_f32 v[24:25], v[40:41], v[20:21] op_sel:[1,1] op_sel_hi:[1,0]
    v_pk_fma_f32 v[28:29], v[30:31], v[16:17], v[22:23] op_sel_hi:[0,1,1]
    v_pk_fma_f32 v[40:41], v[40:41], v[20:21], v[24:25] op_sel_hi:[0,1,1] neg_hi:[0,1,0]
    v_cvt_pk_bf16_f32 v26, v28, v29
    v_cvt_pk_bf16_f32 v27, v40, v41
    ds_write_b32 v6, v26 offset:4352
    ds_write_b32 v6, v27 offset:12784
    v_pk_mul_f32 v[22:23], v[28:29], v[16:17] op_sel:[1,1] op_sel_hi:[1,0] neg_lo:[0,1]
    v_pk_mul_f32 v[24:25], v[32:33], v[20:21] op_sel:[1,1] op_sel_hi:[1,0]
    v_pk_fma_f32 v[30:31], v[28:29], v[16:17], v[22:23] op_sel_hi:[0,1,1]
    v_pk_fma_f32 v[32:33], v[32:33], v[20:21], v[24:25] op_sel_hi:[0,1,1] neg_hi:[0,1,0]
    v_cvt_pk_bf16_f32 v26, v30, v31
    v_cvt_pk_bf16_f32 v27, v32, v33
    ds_write_b32 v6, v26 offset:4624
    ds_write_b32 v6, v27 offset:13056
    v_pk_mul_f32 v[22:23], v[30:31], v[16:17] op_sel:[1,1] op_sel_hi:[1,0] neg_lo:[0,1]
    v_pk_mul_f32 v[24:25], v[32:33], v[20:21] op_sel:[1,1] op_sel_hi:[1,0]
    v_pk_fma_f32 v[28:29], v[30:31], v[16:17], v[22:23] op_sel_hi:[0,1,1]
    v_pk_fma_f32 v[32:33], v[32:33], v[20:21], v[24:25] op_sel_hi:[0,1,1] neg_hi:[0,1,0]
    v_cvt_pk_bf16_f32 v26, v28, v29
    v_cvt_pk_bf16_f32 v27, v32, v33
    ds_write_b32 v6, v26 offset:4896
    ds_write_b32 v6, v27 offset:13328
    v_pk_mul_f32 v[22:23], v[28:29], v[16:17] op_sel:[1,1] op_sel_hi:[1,0] neg_lo:[0,1]
    v_pk_mul_f32 v[24:25], v[32:33], v[20:21] op_sel:[1,1] op_sel_hi:[1,0]
    v_pk_fma_f32 v[30:31], v[28:29], v[16:17], v[22:23] op_sel_hi:[0,1,1]
    v_pk_fma_f32 v[32:33], v[32:33], v[20:21], v[24:25] op_sel_hi:[0,1,1] neg_hi:[0,1,0]
    v_cvt_pk_bf16_f32 v26, v30, v31
    v_cvt_pk_bf16_f32 v27, v32, v33
    ds_write_b32 v6, v26 offset:5168
    ds_write_b32 v6, v27 offset:13600
    v_pk_mul_f32 v[22:23], v[30:31], v[16:17] op_sel:[1,1] op_sel_hi:[1,0] neg_lo:[0,1]
    v_pk_mul_f32 v[24:25], v[32:33], v[20:21] op_sel:[1,1] op_sel_hi:[1,0]
    v_pk_fma_f32 v[28:29], v[30:31], v[16:17], v[22:23] op_sel_hi:[0,1,1]
    v_pk_fma_f32 v[32:33], v[32:33], v[20:21], v[24:25] op_sel_hi:[0,1,1] neg_hi:[0,1,0]
    v_cvt_pk_bf16_f32 v26, v28, v29
    v_cvt_pk_bf16_f32 v27, v32, v33
    ds_write_b32 v6, v26 offset:5440
    ds_write_b32 v6, v27 offset:13872
    v_pk_mul_f32 v[22:23], v[28:29], v[16:17] op_sel:[1,1] op_sel_hi:[1,0] neg_lo:[0,1]
    v_pk_mul_f32 v[24:25], v[32:33], v[20:21] op_sel:[1,1] op_sel_hi:[1,0]
    v_pk_fma_f32 v[30:31], v[28:29], v[16:17], v[22:23] op_sel_hi:[0,1,1]
    v_pk_fma_f32 v[32:33], v[32:33], v[20:21], v[24:25] op_sel_hi:[0,1,1] neg_hi:[0,1,0]
    v_cvt_pk_bf16_f32 v26, v30, v31
    v_cvt_pk_bf16_f32 v27, v32, v33
    ds_write_b32 v6, v26 offset:5712
    ds_write_b32 v6, v27 offset:14144
    v_pk_mul_f32 v[22:23], v[30:31], v[16:17] op_sel:[1,1] op_sel_hi:[1,0] neg_lo:[0,1]
    v_pk_fma_f32 v[28:29], v[30:31], v[16:17], v[22:23] op_sel_hi:[0,1,1]
    v_cvt_pk_bf16_f32 v26, v28, v29
    ds_write_b32 v6, v26 offset:5984
    v_pk_mul_f32 v[22:23], v[28:29], v[16:17] op_sel:[1,1] op_sel_hi:[1,0] neg_lo:[0,1]
    v_pk_fma_f32 v[30:31], v[28:29], v[16:17], v[22:23] op_sel_hi:[0,1,1]
    v_cvt_pk_bf16_f32 v26, v30, v31
    ds_write_b32 v6, v26 offset:6256
    v_pk_mul_f32 v[22:23], v[30:31], v[16:17] op_sel:[1,1] op_sel_hi:[1,0] neg_lo:[0,1]
    v_pk_fma_f32 v[28:29], v[30:31], v[16:17], v[22:23] op_sel_hi:[0,1,1]
    v_cvt_pk_bf16_f32 v26, v28, v29
    ds_write_b32 v6, v26 offset:6528
    v_pk_mul_f32 v[22:23], v[28:29], v[16:17] op_sel:[1,1] op_sel_hi:[1,0] neg_lo:[0,1]
    v_pk_fma_f32 v[30:31], v[28:29], v[16:17], v[22:23] op_sel_hi:[0,1,1]
    v_cvt_pk_bf16_f32 v26, v30, v31
    ds_write_b32 v6, v26 offset:6800
    v_pk_mul_f32 v[22:23], v[30:31], v[16:17] op_sel:[1,1] op_sel_hi:[1,0] neg_lo:[0,1]
    v_pk_fma_f32 v[28:29], v[30:31], v[16:17], v[22:23] op_sel_hi:[0,1,1]
    v_cvt_pk_bf16_f32 v26, v28, v29
    ds_write_b32 v6, v26 offset:7072
    v_pk_mul_f32 v[22:23], v[28:29], v[16:17] op_sel:[1,1] op_sel_hi:[1,0] neg_lo:[0,1]
    v_pk_fma_f32 v[30:31], v[28:29], v[16:17], v[22:23] op_sel_hi:[0,1,1]
    v_cvt_pk_bf16_f32 v26, v30, v31
    ds_write_b32 v6, v26 offset:7344
    v_pk_mul_f32 v[22:23], v[30:31], v[16:17] op_sel:[1,1] op_sel_hi:[1,0] neg_lo:[0,1]
    v_pk_fma_f32 v[28:29], v[30:31], v[16:17], v[22:23] op_sel_hi:[0,1,1]
    v_cvt_pk_bf16_f32 v26, v28, v29
    ds_write_b32 v6, v26 offset:7616
    v_pk_mul_f32 v[22:23], v[28:29], v[16:17] op_sel:[1,1] op_sel_hi:[1,0] neg_lo:[0,1]
    v_pk_fma_f32 v[30:31], v[28:29], v[16:17], v[22:23] op_sel_hi:[0,1,1]
    v_cvt_pk_bf16_f32 v26, v30, v31
    ds_write_b32 v6, v26 offset:7888
    v_pk_mul_f32 v[22:23], v[30:31], v[16:17] op_sel:[1,1] op_sel_hi:[1,0] neg_lo:[0,1]
    v_pk_fma_f32 v[28:29], v[30:31], v[16:17], v[22:23] op_sel_hi:[0,1,1]
    v_cvt_pk_bf16_f32 v26, v28, v29
    ds_write_b32 v6, v26 offset:8160
    v_pk_mul_f32 v[22:23], v[28:29], v[16:17] op_sel:[1,1] op_sel_hi:[1,0] neg_lo:[0,1]
    v_pk_fma_f32 v[30:31], v[28:29], v[16:17], v[22:23] op_sel_hi:[0,1,1]
    v_cvt_pk_bf16_f32 v26, v30, v31
    ds_write_b32 v6, v26 offset:8432
    ds_read_b128 v[64:67], v60 offset:8704
    ds_read_b128 v[96:99], v61 offset:0
    ds_read_b128 v[68:71], v60 offset:8736
    ds_read_b128 v[100:103], v61 offset:32
    ds_read_b128 v[72:75], v60 offset:8768
    ds_read_b128 v[104:107], v61 offset:64
    ds_read_b128 v[76:79], v60 offset:8800
    ds_read_b128 v[108:111], v61 offset:96
    ds_read_b128 v[80:83], v60 offset:8832
    ds_read_b128 v[112:115], v61 offset:128
    ds_read_b128 v[84:87], v60 offset:8864
    ds_read_b128 v[116:119], v61 offset:160
    ds_read_b128 v[88:91], v60 offset:8896
    ds_read_b128 v[120:123], v61 offset:192
    ds_read_b128 v[92:95], v60 offset:8928
    ds_read_b128 v[124:127], v61 offset:224
    s_waitcnt lgkmcnt(0)
    v_mfma_f32_32x32x16_bf16 v[128:143], v[64:67], v[96:99], v[128:143]
    v_mfma_f32_32x32x16_bf16 v[128:143], v[68:71], v[100:103], v[128:143]
    v_mfma_f32_32x32x16_bf16 v[128:143], v[72:75], v[104:107], v[128:143]
    v_mfma_f32_32x32x16_bf16 v[128:143], v[76:79], v[108:111], v[128:143]
    v_mfma_f32_32x32x16_bf16 v[128:143], v[80:83], v[112:115], v[128:143]
    v_mfma_f32_32x32x16_bf16 v[128:143], v[84:87], v[116:119], v[128:143]
    v_mfma_f32_32x32x16_bf16 v[128:143], v[88:91], v[120:123], v[128:143]
    v_mfma_f32_32x32x16_bf16 v[128:143], v[92:95], v[124:127], v[128:143]
    v_lshrrev_b32 v8, 5, v0
    v_and_b32 v9, 31, v0
    v_lshlrev_b32 v3, 11, v8
    v_lshl_add_u32 v3, v9, 4, v3
    v_lshrrev_b32 v5, 2, v3
    v_bfe_u32 v8, v1, 4, 1
    v_lshrrev_b32 v9, 5, v1
    v_bfe_u32 v10, v1, 2, 2
    v_and_b32 v11, 3, v1
    v_lshlrev_b32 v6, 5, v8
    v_lshl_add_u32 v6, v11, 3, v6
    v_lshlrev_b32 v12, 6, v9
    v_lshl_add_u32 v12, v10, 3, v12
    v_sub_u32 v6, v6, v12
    s_add_u32 s3, s38, 160
    v_add_u32 v6, s3, v6
    v_lshlrev_b32 v7, 8, v8
    v_lshl_add_u32 v7, v11, 6, v7
    v_add_u32 v7, v7, v12
    s_mul_i32 s33, s32, 4608
    s_add_u32 s3, s33, 16960
    v_add_u32 v7, s3, v7
    v_cvt_pk_bf16_f32 v16, v128, v129
    v_cvt_pk_bf16_f32 v17, v130, v131
    v_cvt_pk_bf16_f32 v18, v132, v133
    v_cvt_pk_bf16_f32 v19, v134, v135
    v_cvt_pk_bf16_f32 v20, v136, v137
    v_cvt_pk_bf16_f32 v21, v138, v139
    ds_write_b64 v48, v[16:17]
    ds_write_b16 v49, v18 offset:512
    ds_write_b16_d16_hi v50, v18 offset:516
    ds_write_b16 v51, v19 offset:520
    ds_write_b16_d16_hi v52, v19 offset:524
    ds_write_b16 v53, v20 offset:2048
    ds_write_b16_d16_hi v54, v20 offset:2560
    ds_write_b16 v55, v21 offset:3072
    ds_write_b16_d16_hi v56, v21 offset:3584
    ds_read_b128 v[16:19], v62
    ds_read_b32 v20, v62 offset:16
    ds_read_b32 v21, v62 offset:1024
    ds_read_b32 v22, v62 offset:1032
    ds_read_b32 v23, v62 offset:1040
    ds_read_b32 v24, v62 offset:2048
    ds_read_b32 v25, v62 offset:2064
    ds_read_b32 v26, v62 offset:3072
    ds_read_b32 v27, v62 offset:3088
    s_waitcnt lgkmcnt(0)
    v_perm_b32 v32, v17, v16, v57
    v_perm_b32 v33, v18, v17, v58
    v_perm_b32 v34, v19, v18, v57
    v_perm_b32 v35, v20, v19, v58
    v_perm_b32 v36, v21, v21, s56
    v_perm_b32 v37, v22, v21, s57
    v_perm_b32 v38, v22, v22, s56
    v_perm_b32 v39, v23, v23, s56
    v_perm_b32 v40, v24, v24, s56
    v_perm_b32 v41, v24, v24, s56
    v_perm_b32 v42, v25, v24, v59
    v_perm_b32 v43, v25, v25, s56
    v_perm_b32 v44, v26, v26, s56
    v_perm_b32 v45, v26, v26, s56
    v_perm_b32 v46, v27, v26, v59
    v_perm_b32 v47, v27, v27, s56
    ds_write_b128 v63, v[32:35] offset:128
    ds_write_b128 v63, v[36:39] offset:1152
    ds_write_b128 v63, v[40:43] offset:2176
    ds_write_b128 v63, v[44:47] offset:3200
    s_cmp_lg_u32 s32, 0
    s_cbranch_scc1 f_pc_ok
    s_lshr_b32 s3, s2, 4
    s_add_u32 s3, s3, 128
    v_and_b32 v8, 1, v1
    v_mul_u32_u24 v8, 60, v8
    v_bfe_u32 v9, v1, 1, 2
    v_min_u32 v9, 2, v9
    v_mul_u32_u24 v9, 10, v9
    v_add3_u32 v10, v8, v9, s3
    s_add_u32 s64, s4, 114688
    s_addc_u32 s65, s5, 0
    s_mov_b32 s66, 4096
    s_mov_b32 s67, 0x00020000
    v_mov_b32 v8, 0
f_g3:
    buffer_load_dword v9, v8, s[28:31], 0 offen sc1
    s_waitcnt vmcnt(0)
    v_readfirstlane_b32 s60, v9
    s_cmp_lg_u32 s60, 0
    s_cbranch_scc1 f_g3_ok
    s_sleep 2
    s_branch f_g3
f_g3_ok:
    v_lshlrev_b32 v8, 4, v10
    v_lshlrev_b32 v9, 4, v1
f_pc:
    buffer_load_dword v96, v8, s[64:67], 0 offen offset:0 sc1
    buffer_load_dword v97, v9, s[64:67], 0 offen offset:0 sc1
    buffer_load_dword v98, v9, s[64:67], 0 offen offset:1024 sc1
    s_waitcnt vmcnt(0)
    v_and_b32 v96, v96, v97
    v_and_b32 v96, v96, v98
    v_cmp_eq_u32 vcc, 1, v96
    s_nop 4
    s_cmp_eq_u64 vcc, -1
    s_cbranch_scc1 f_pc_ok
    s_sleep 4
    s_branch f_pc
f_pc_ok:
    s_waitcnt lgkmcnt(0)
    s_barrier
    s_lshl_b32 s24, s2, 14
    s_lshl_b32 s3, s2, 4
    v_mov_b32 v8, 0
    v_mov_b32 v9, 0
    s_add_u32 s25, s3, 0
    buffer_load_dwordx4 v[96:99], v8, s[48:51], s25 offen sc1
    s_add_u32 s25, s3, 15360
    buffer_load_dwordx4 v[100:103], v8, s[48:51], s25 offen sc1
    s_add_u32 s25, s3, 2560
    buffer_load_dwordx4 v[104:107], v8, s[48:51], s25 offen sc1
    s_add_u32 s25, s3, 17920
    buffer_load_dwordx4 v[108:111], v8, s[48:51], s25 offen sc1
    s_add_u32 s25, s3, 5120
    buffer_load_dwordx4 v[112:115], v8, s[48:51], s25 offen sc1
    s_add_u32 s25, s3, 20480
    buffer_load_dwordx4 v[116:119], v8, s[48:51], s25 offen sc1
    buffer_load_dwordx4 v[16:19], v3, s[40:43], s24 offen offset:0 sc1
    buffer_load_dwordx4 v[64:67], v3, s[44:47], 0 offen offset:0 sc1
    buffer_load_dwordx4 v[20:23], v3, s[40:43], s24 offen offset:512 sc1
    buffer_load_dwordx4 v[68:71], v3, s[44:47], 0 offen offset:512 sc1
    buffer_load_dwordx4 v[24:27], v3, s[40:43], s24 offen offset:1024 sc1
    buffer_load_dwordx4 v[72:75], v3, s[44:47], 0 offen offset:1024 sc1
    buffer_load_dwordx4 v[28:31], v3, s[40:43], s24 offen offset:1536 sc1
    buffer_load_dwordx4 v[76:79], v3, s[44:47], 0 offen offset:1536 sc1
    v_lshl_add_u32 v10, v1, 3, s33
    ds_write_b64 v10, v[8:9] offset:16896
    s_lshl_b32 s38, s36, 16
    s_and_b32 s39, s36, 0xffff0000
    s_lshl_b32 s36, s37, 16
    s_and_b32 s37, s37, 0xffff0000
    s_mov_b32 s58, 0
    s_brev_b32 s59, 1
    s_lshl_b32 s3, s32, 12
    s_add_u32 s3, s3, 35328
    v_lshl_add_u32 v4, v1, 3, s3
    s_waitcnt vmcnt(8)
    v_add_f32 v48, v96, v100
    v_cvt_pk_bf16_f32 v48, v48, v48
    v_lshlrev_b32 v48, 16, v48
    v_add_f32 v49, v97, v101
    v_cvt_pk_bf16_f32 v49, v49, v49
    v_lshlrev_b32 v49, 16, v49
    v_add_f32 v50, v98, v102
    v_cvt_pk_bf16_f32 v50, v50, v50
    v_lshlrev_b32 v50, 16, v50
    v_add_f32 v51, v99, v103
    v_cvt_pk_bf16_f32 v51, v51, v51
    v_lshlrev_b32 v51, 16, v51
    v_add_f32 v52, v104, v108
    v_cvt_pk_bf16_f32 v52, v52, v52
    v_lshlrev_b32 v52, 16, v52
    v_add_f32 v52, 1.0, v52
    v_cvt_pk_bf16_f32 v52, v52, v52
    v_lshlrev_b32 v52, 16, v52
    v_add_f32 v53, v105, v109
    v_cvt_pk_bf16_f32 v53, v53, v53
    v_lshlrev_b32 v53, 16, v53
    v_add_f32 v53, 1.0, v53
    v_cvt_pk_bf16_f32 v53, v53, v53
    v_lshlrev_b32 v53, 16, v53
    v_add_f32 v54, v106, v110
    v_cvt_pk_bf16_f32 v54, v54, v54
    v_lshlrev_b32 v54, 16, v54
    v_add_f32 v54, 1.0, v54
    v_cvt_pk_bf16_f32 v54, v54, v54
    v_lshlrev_b32 v54, 16, v54
    v_add_f32 v55, v107, v111
    v_cvt_pk_bf16_f32 v55, v55, v55
    v_lshlrev_b32 v55, 16, v55
    v_add_f32 v55, 1.0, v55
    v_cvt_pk_bf16_f32 v55, v55, v55
    v_lshlrev_b32 v55, 16, v55
    v_add_f32 v56, v112, v116
    v_cvt_pk_bf16_f32 v56, v56, v56
    v_lshlrev_b32 v56, 16, v56
    v_add_f32 v57, v113, v117
    v_cvt_pk_bf16_f32 v57, v57, v57
    v_lshlrev_b32 v57, 16, v57
    v_add_f32 v58, v114, v118
    v_cvt_pk_bf16_f32 v58, v58, v58
    v_lshlrev_b32 v58, 16, v58
    v_add_f32 v59, v115, v119
    v_cvt_pk_bf16_f32 v59, v59, v59
    v_lshlrev_b32 v59, 16, v59
    s_waitcnt vmcnt(6)
    v_mul_f32 v64, v64, -v65
    v_lshlrev_b32 v8, 16, v16
    v_and_b32 v9, 0xffff0000, v16
    v_pk_fma_f32 v[8:9], v[8:9], v[64:65], v[64:65] op_sel:[0,1,0] op_sel_hi:[1,1,0]
    v_pk_fma_f32 v[8:9], v[8:9], v[52:53], v[48:49]
    v_lshlrev_b32 v10, 16, v17
    v_and_b32 v11, 0xffff0000, v17
    v_pk_fma_f32 v[10:11], v[10:11], v[64:65], v[64:65] op_sel:[0,1,0] op_sel_hi:[1,1,0]
    v_pk_fma_f32 v[10:11], v[10:11], v[54:55], v[50:51]
    v_mul_f32 v66, v66, -v67
    v_lshlrev_b32 v12, 16, v18
    v_and_b32 v13, 0xffff0000, v18
    v_pk_fma_f32 v[12:13], v[12:13], v[66:67], v[66:67] op_sel:[0,1,0] op_sel_hi:[1,1,0]
    v_pk_fma_f32 v[12:13], v[12:13], v[52:53], v[48:49]
    v_lshlrev_b32 v14, 16, v19
    v_and_b32 v15, 0xffff0000, v19
    v_pk_fma_f32 v[14:15], v[14:15], v[66:67], v[66:67] op_sel:[0,1,0] op_sel_hi:[1,1,0]
    v_pk_fma_f32 v[14:15], v[14:15], v[54:55], v[50:51]
    v_cvt_pk_bf16_f32 v32, v8, v12
    ds_write_b32 v5, v32 offset:17408
    v_cvt_pk_bf16_f32 v33, v9, v13
    ds_write_b32 v5, v33 offset:22016
    v_cvt_pk_bf16_f32 v34, v10, v14
    ds_write_b32 v5, v34 offset:26624
    v_cvt_pk_bf16_f32 v35, v11, v15
    ds_write_b32 v5, v35 offset:31232
    s_waitcnt vmcnt(4)
    v_mul_f32 v68, v68, -v69
    v_lshlrev_b32 v8, 16, v20
    v_and_b32 v9, 0xffff0000, v20
    v_pk_fma_f32 v[8:9], v[8:9], v[68:69], v[68:69] op_sel:[0,1,0] op_sel_hi:[1,1,0]
    v_pk_fma_f32 v[8:9], v[8:9], v[52:53], v[48:49]
    v_lshlrev_b32 v10, 16, v21
    v_and_b32 v11, 0xffff0000, v21
    v_pk_fma_f32 v[10:11], v[10:11], v[68:69], v[68:69] op_sel:[0,1,0] op_sel_hi:[1,1,0]
    v_pk_fma_f32 v[10:11], v[10:11], v[54:55], v[50:51]
    v_mul_f32 v70, v70, -v71
    v_lshlrev_b32 v12, 16, v22
    v_and_b32 v13, 0xffff0000, v22
    v_pk_fma_f32 v[12:13], v[12:13], v[70:71], v[70:71] op_sel:[0,1,0] op_sel_hi:[1,1,0]
    v_pk_fma_f32 v[12:13], v[12:13], v[52:53], v[48:49]
    v_lshlrev_b32 v14, 16, v23
    v_and_b32 v15, 0xffff0000, v23
    v_pk_fma_f32 v[14:15], v[14:15], v[70:71], v[70:71] op_sel:[0,1,0] op_sel_hi:[1,1,0]
    v_pk_fma_f32 v[14:15], v[14:15], v[54:55], v[50:51]
    v_cvt_pk_bf16_f32 v36, v8, v12
    ds_write_b32 v5, v36 offset:17536
    v_cvt_pk_bf16_f32 v37, v9, v13
    ds_write_b32 v5, v37 offset:22144
    v_cvt_pk_bf16_f32 v38, v10, v14
    ds_write_b32 v5, v38 offset:26752
    v_cvt_pk_bf16_f32 v39, v11, v15
    ds_write_b32 v5, v39 offset:31360
    s_waitcnt vmcnt(2)
    v_mul_f32 v72, v72, -v73
    v_lshlrev_b32 v8, 16, v24
    v_and_b32 v9, 0xffff0000, v24
    v_pk_fma_f32 v[8:9], v[8:9], v[72:73], v[72:73] op_sel:[0,1,0] op_sel_hi:[1,1,0]
    v_pk_fma_f32 v[8:9], v[8:9], v[52:53], v[48:49]
    v_lshlrev_b32 v10, 16, v25
    v_and_b32 v11, 0xffff0000, v25
    v_pk_fma_f32 v[10:11], v[10:11], v[72:73], v[72:73] op_sel:[0,1,0] op_sel_hi:[1,1,0]
    v_pk_fma_f32 v[10:11], v[10:11], v[54:55], v[50:51]
    v_mul_f32 v74, v74, -v75
    v_lshlrev_b32 v12, 16, v26
    v_and_b32 v13, 0xffff0000, v26
    v_pk_fma_f32 v[12:13], v[12:13], v[74:75], v[74:75] op_sel:[0,1,0] op_sel_hi:[1,1,0]
    v_pk_fma_f32 v[12:13], v[12:13], v[52:53], v[48:49]
    v_lshlrev_b32 v14, 16, v27
    v_and_b32 v15, 0xffff0000, v27
    v_pk_fma_f32 v[14:15], v[14:15], v[74:75], v[74:75] op_sel:[0,1,0] op_sel_hi:[1,1,0]
    v_pk_fma_f32 v[14:15], v[14:15], v[54:55], v[50:51]
    v_cvt_pk_bf16_f32 v40, v8, v12
    ds_write_b32 v5, v40 offset:17664
    v_cvt_pk_bf16_f32 v41, v9, v13
    ds_write_b32 v5, v41 offset:22272
    v_cvt_pk_bf16_f32 v42, v10, v14
    ds_write_b32 v5, v42 offset:26880
    v_cvt_pk_bf16_f32 v43, v11, v15
    ds_write_b32 v5, v43 offset:31488
    s_waitcnt vmcnt(0)
    v_mul_f32 v76, v76, -v77
    v_lshlrev_b32 v8, 16, v28
    v_and_b32 v9, 0xffff0000, v28
    v_pk_fma_f32 v[8:9], v[8:9], v[76:77], v[76:77] op_sel:[0,1,0] op_sel_hi:[1,1,0]
    v_pk_fma_f32 v[8:9], v[8:9], v[52:53], v[48:49]
    v_lshlrev_b32 v10, 16, v29
    v_and_b32 v11, 0xffff0000, v29
    v_pk_fma_f32 v[10:11], v[10:11], v[76:77], v[76:77] op_sel:[0,1,0] op_sel_hi:[1,1,0]
    v_pk_fma_f32 v[10:11], v[10:11], v[54:55], v[50:51]
    v_mul_f32 v78, v78, -v79
    v_lshlrev_b32 v12, 16, v30
    v_and_b32 v13, 0xffff0000, v30
    v_pk_fma_f32 v[12:13], v[12:13], v[78:79], v[78:79] op_sel:[0,1,0] op_sel_hi:[1,1,0]
    v_pk_fma_f32 v[12:13], v[12:13], v[52:53], v[48:49]
    v_lshlrev_b32 v14, 16, v31
    v_and_b32 v15, 0xffff0000, v31
    v_pk_fma_f32 v[14:15], v[14:15], v[78:79], v[78:79] op_sel:[0,1,0] op_sel_hi:[1,1,0]
    v_pk_fma_f32 v[14:15], v[14:15], v[54:55], v[50:51]
    v_cvt_pk_bf16_f32 v44, v8, v12
    ds_write_b32 v5, v44 offset:17792
    v_cvt_pk_bf16_f32 v45, v9, v13
    ds_write_b32 v5, v45 offset:22400
    v_cvt_pk_bf16_f32 v46, v10, v14
    ds_write_b32 v5, v46 offset:27008
    v_cvt_pk_bf16_f32 v47, v11, v15
    ds_write_b32 v5, v47 offset:31616
    s_waitcnt lgkmcnt(0)
    s_barrier
    ds_read_b64_tr_b16 v[64:65], v6 offset:32
    ds_read_b64_tr_b16 v[66:67], v6 offset:0
    ds_read_b64_tr_b16 v[68:69], v7 offset:384
    ds_read_b64_tr_b16 v[70:71], v7 offset:416
    ds_read_b64_tr_b16 v[72:73], v7 offset:896
    ds_read_b64_tr_b16 v[74:75], v7 offset:928
    ds_read_b64_tr_b16 v[76:77], v7 offset:1408
    ds_read_b64_tr_b16 v[78:79], v7 offset:1440
    ds_read_b64_tr_b16 v[80:81], v7 offset:1920
    ds_read_b64_tr_b16 v[82:83], v7 offset:1952
    ds_read_b64_tr_b16 v[84:85], v7 offset:2432
    ds_read_b64_tr_b16 v[86:87], v7 offset:2464
    s_waitcnt lgkmcnt(8)
    v_mfma_f32_32x32x16_bf16 v[128:143], v[68:71], v[64:67], 0
    ds_read_b64_tr_b16 v[88:89], v7 offset:2944
    ds_read_b64_tr_b16 v[90:91], v7 offset:2976
    s_waitcnt lgkmcnt(8)
    v_mfma_f32_32x32x16_bf16 v[144:159], v[72:75], v[64:67], 0
    ds_read_b64_tr_b16 v[92:93], v7 offset:3456
    ds_read_b64_tr_b16 v[94:95], v7 offset:3488
    s_waitcnt lgkmcnt(8)
    v_mfma_f32_32x32x16_bf16 v[160:175], v[76:79], v[64:67], 0
    ds_read_b64_tr_b16 v[96:97], v7 offset:3968
    ds_read_b64_tr_b16 v[98:99], v7 offset:4000
    s_waitcnt lgkmcnt(8)
    v_mfma_f32_32x32x16_bf16 v[176:191], v[80:83], v[64:67], 0
    ds_read_b64_tr_b16 v[100:101], v6 offset:544
    ds_read_b64_tr_b16 v[102:103], v6 offset:512
    s_waitcnt lgkmcnt(8)
    v_mfma_f32_32x32x16_bf16 v[192:207], v[84:87], v[64:67], 0
    ds_read_b64_tr_b16 v[104:105], v6 offset:1056
    ds_read_b64_tr_b16 v[106:107], v6 offset:1024
    s_waitcnt lgkmcnt(8)
    v_mfma_f32_32x32x16_bf16 v[208:223], v[88:91], v[64:67], 0
    ds_read_b64_tr_b16 v[108:109], v6 offset:1568
    ds_read_b64_tr_b16 v[110:111], v6 offset:1536
    s_waitcnt lgkmcnt(8)
    v_mfma_f32_32x32x16_bf16 v[224:239], v[92:95], v[64:67], 0
    ds_read_b64_tr_b16 v[112:113], v6 offset:2080
    ds_read_b64_tr_b16 v[114:115], v6 offset:2048
    s_waitcnt lgkmcnt(8)
    v_mfma_f32_32x32x16_bf16 v[240:255], v[96:99], v[64:67], 0
    ds_read_b64_tr_b16 v[116:117], v6 offset:2592
    ds_read_b64_tr_b16 v[118:119], v6 offset:2560
    s_waitcnt lgkmcnt(8)
    v_mfma_f32_32x32x16_bf16 v[144:159], v[68:71], v[100:103], v[144:159]
    ds_read_b64_tr_b16 v[120:121], v6 offset:3104
    ds_read_b64_tr_b16 v[122:123], v6 offset:3072
    v_mfma_f32_32x32x16_bf16 v[160:175], v[72:75], v[100:103], v[160:175]
    ds_read_b64_tr_b16 v[124:125], v6 offset:3616
    ds_read_b64_tr_b16 v[126:127], v6 offset:3584
    v_mfma_f32_32x32x16_bf16 v[176:191], v[76:79], v[100:103], v[176:191]
    v_mfma_f32_32x32x16_bf16 v[192:207], v[80:83], v[100:103], v[192:207]
    v_mfma_f32_32x32x16_bf16 v[208:223], v[84:87], v[100:103], v[208:223]
    v_mfma_f32_32x32x16_bf16 v[224:239], v[88:91], v[100:103], v[224:239]
    v_mfma_f32_32x32x16_bf16 v[240:255], v[92:95], v[100:103], v[240:255]
    s_waitcnt lgkmcnt(10)
    v_mfma_f32_32x32x16_bf16 v[160:175], v[68:71], v[104:107], v[160:175]
    ds_read_b64_tr_b16 v[64:65], v6 offset:160
    ds_read_b64_tr_b16 v[66:67], v6 offset:128
    v_mfma_f32_32x32x16_bf16 v[176:191], v[72:75], v[104:107], v[176:191]
    v_mfma_f32_32x32x16_bf16 v[192:207], v[76:79], v[104:107], v[192:207]
    v_mfma_f32_32x32x16_bf16 v[208:223], v[80:83], v[104:107], v[208:223]
    v_mfma_f32_32x32x16_bf16 v[224:239], v[84:87], v[104:107], v[224:239]
    v_mfma_f32_32x32x16_bf16 v[240:255], v[88:91], v[104:107], v[240:255]
    s_waitcnt lgkmcnt(10)
    v_mfma_f32_32x32x16_bf16 v[176:191], v[68:71], v[108:111], v[176:191]
    ds_read_b64_tr_b16 v[96:97], v7 offset:256
    ds_read_b64_tr_b16 v[98:99], v7 offset:288
    v_mfma_f32_32x32x16_bf16 v[192:207], v[72:75], v[108:111], v[192:207]
    v_mfma_f32_32x32x16_bf16 v[208:223], v[76:79], v[108:111], v[208:223]
    v_mfma_f32_32x32x16_bf16 v[224:239], v[80:83], v[108:111], v[224:239]
    v_mfma_f32_32x32x16_bf16 v[240:255], v[84:87], v[108:111], v[240:255]
    s_waitcnt lgkmcnt(10)
    v_mfma_f32_32x32x16_bf16 v[192:207], v[68:71], v[112:115], v[192:207]
    ds_read_b64_tr_b16 v[100:101], v7 offset:768
    ds_read_b64_tr_b16 v[102:103], v7 offset:800
    v_mfma_f32_32x32x16_bf16 v[208:223], v[72:75], v[112:115], v[208:223]
    v_mfma_f32_32x32x16_bf16 v[224:239], v[76:79], v[112:115], v[224:239]
    v_mfma_f32_32x32x16_bf16 v[240:255], v[80:83], v[112:115], v[240:255]
    s_waitcnt lgkmcnt(10)
    v_mfma_f32_32x32x16_bf16 v[208:223], v[68:71], v[116:119], v[208:223]
    ds_read_b64_tr_b16 v[92:93], v7 offset:1280
    ds_read_b64_tr_b16 v[94:95], v7 offset:1312
    v_mfma_f32_32x32x16_bf16 v[224:239], v[72:75], v[116:119], v[224:239]
    v_mfma_f32_32x32x16_bf16 v[240:255], v[76:79], v[116:119], v[240:255]
    s_waitcnt lgkmcnt(10)
    v_mfma_f32_32x32x16_bf16 v[224:239], v[68:71], v[120:123], v[224:239]
    ds_read_b64_tr_b16 v[104:105], v7 offset:1792
    ds_read_b64_tr_b16 v[106:107], v7 offset:1824
    v_mfma_f32_32x32x16_bf16 v[240:255], v[72:75], v[120:123], v[240:255]
    s_waitcnt lgkmcnt(10)
    v_mfma_f32_32x32x16_bf16 v[240:255], v[68:71], v[124:127], v[240:255]
    ds_read_b64_tr_b16 v[88:89], v7 offset:2304
    ds_read_b64_tr_b16 v[90:91], v7 offset:2336
    s_waitcnt lgkmcnt(8)
    v_mfma_f32_32x32x16_bf16 v[128:143], v[96:99], v[64:67], v[128:143]
    ds_read_b64_tr_b16 v[108:109], v7 offset:2816
    ds_read_b64_tr_b16 v[110:111], v7 offset:2848
    s_waitcnt lgkmcnt(8)
    v_mfma_f32_32x32x16_bf16 v[144:159], v[100:103], v[64:67], v[144:159]
    ds_read_b64_tr_b16 v[84:85], v7 offset:3328
    ds_read_b64_tr_b16 v[86:87], v7 offset:3360
    s_waitcnt lgkmcnt(8)
    v_mfma_f32_32x32x16_bf16 v[160:175], v[92:95], v[64:67], v[160:175]
    ds_read_b64_tr_b16 v[112:113], v7 offset:3840
    ds_read_b64_tr_b16 v[114:115], v7 offset:3872
    s_waitcnt lgkmcnt(8)
    v_mfma_f32_32x32x16_bf16 v[176:191], v[104:107], v[64:67], v[176:191]
    ds_read_b64_tr_b16 v[80:81], v6 offset:672
    ds_read_b64_tr_b16 v[82:83], v6 offset:640
    s_waitcnt lgkmcnt(8)
    v_mfma_f32_32x32x16_bf16 v[192:207], v[88:91], v[64:67], v[192:207]
    ds_read_b64_tr_b16 v[116:117], v6 offset:1184
    ds_read_b64_tr_b16 v[118:119], v6 offset:1152
    s_waitcnt lgkmcnt(8)
    v_mfma_f32_32x32x16_bf16 v[208:223], v[108:111], v[64:67], v[208:223]
    ds_read_b64_tr_b16 v[76:77], v6 offset:1696
    ds_read_b64_tr_b16 v[78:79], v6 offset:1664
    s_waitcnt lgkmcnt(8)
    v_mfma_f32_32x32x16_bf16 v[224:239], v[84:87], v[64:67], v[224:239]
    ds_read_b64_tr_b16 v[120:121], v6 offset:2208
    ds_read_b64_tr_b16 v[122:123], v6 offset:2176
    s_waitcnt lgkmcnt(8)
    v_mfma_f32_32x32x16_bf16 v[240:255], v[112:115], v[64:67], v[240:255]
    ds_read_b64_tr_b16 v[72:73], v6 offset:2720
    ds_read_b64_tr_b16 v[74:75], v6 offset:2688
    s_waitcnt lgkmcnt(8)
    v_mfma_f32_32x32x16_bf16 v[144:159], v[96:99], v[80:83], v[144:159]
    ds_read_b64_tr_b16 v[124:125], v6 offset:3232
    ds_read_b64_tr_b16 v[126:127], v6 offset:3200
    v_mfma_f32_32x32x16_bf16 v[160:175], v[100:103], v[80:83], v[160:175]
    ds_read_b64_tr_b16 v[68:69], v6 offset:3744
    ds_read_b64_tr_b16 v[70:71], v6 offset:3712
    v_mfma_f32_32x32x16_bf16 v[176:191], v[92:95], v[80:83], v[176:191]
    v_mfma_f32_32x32x16_bf16 v[192:207], v[104:107], v[80:83], v[192:207]
    v_mfma_f32_32x32x16_bf16 v[208:223], v[88:91], v[80:83], v[208:223]
    v_mfma_f32_32x32x16_bf16 v[224:239], v[108:111], v[80:83], v[224:239]
    v_mfma_f32_32x32x16_bf16 v[240:255], v[84:87], v[80:83], v[240:255]
    s_waitcnt lgkmcnt(10)
    v_mfma_f32_32x32x16_bf16 v[160:175], v[96:99], v[116:119], v[160:175]
    ds_read_b64_tr_b16 v[64:65], v6 offset:288
    ds_read_b64_tr_b16 v[66:67], v6 offset:256
    v_mfma_f32_32x32x16_bf16 v[176:191], v[100:103], v[116:119], v[176:191]
    v_mfma_f32_32x32x16_bf16 v[192:207], v[92:95], v[116:119], v[192:207]
    v_mfma_f32_32x32x16_bf16 v[208:223], v[104:107], v[116:119], v[208:223]
    v_mfma_f32_32x32x16_bf16 v[224:239], v[88:91], v[116:119], v[224:239]
    v_mfma_f32_32x32x16_bf16 v[240:255], v[108:111], v[116:119], v[240:255]
    s_waitcnt lgkmcnt(10)
    v_mfma_f32_32x32x16_bf16 v[176:191], v[96:99], v[76:79], v[176:191]
    ds_read_b64_tr_b16 v[112:113], v7 offset:128
    ds_read_b64_tr_b16 v[114:115], v7 offset:160
    v_mfma_f32_32x32x16_bf16 v[192:207], v[100:103], v[76:79], v[192:207]
    v_mfma_f32_32x32x16_bf16 v[208:223], v[92:95], v[76:79], v[208:223]
    v_mfma_f32_32x32x16_bf16 v[224:239], v[104:107], v[76:79], v[224:239]
    v_mfma_f32_32x32x16_bf16 v[240:255], v[88:91], v[76:79], v[240:255]
    s_waitcnt lgkmcnt(10)
    v_mfma_f32_32x32x16_bf16 v[192:207], v[96:99], v[120:123], v[192:207]
    ds_read_b64_tr_b16 v[80:81], v7 offset:640
    ds_read_b64_tr_b16 v[82:83], v7 offset:672
    v_mfma_f32_32x32x16_bf16 v[208:223], v[100:103], v[120:123], v[208:223]
    v_mfma_f32_32x32x16_bf16 v[224:239], v[92:95], v[120:123], v[224:239]
    v_mfma_f32_32x32x16_bf16 v[240:255], v[104:107], v[120:123], v[240:255]
    s_waitcnt lgkmcnt(10)
    v_mfma_f32_32x32x16_bf16 v[208:223], v[96:99], v[72:75], v[208:223]
    ds_read_b64_tr_b16 v[84:85], v7 offset:1152
    ds_read_b64_tr_b16 v[86:87], v7 offset:1184
    v_mfma_f32_32x32x16_bf16 v[224:239], v[100:103], v[72:75], v[224:239]
    v_mfma_f32_32x32x16_bf16 v[240:255], v[92:95], v[72:75], v[240:255]
    s_waitcnt lgkmcnt(10)
    v_mfma_f32_32x32x16_bf16 v[224:239], v[96:99], v[124:127], v[224:239]
    ds_read_b64_tr_b16 v[116:117], v7 offset:1664
    ds_read_b64_tr_b16 v[118:119], v7 offset:1696
    v_mfma_f32_32x32x16_bf16 v[240:255], v[100:103], v[124:127], v[240:255]
    s_waitcnt lgkmcnt(10)
    v_mfma_f32_32x32x16_bf16 v[240:255], v[96:99], v[68:71], v[240:255]
    ds_read_b64_tr_b16 v[108:109], v7 offset:2176
    ds_read_b64_tr_b16 v[110:111], v7 offset:2208
    s_waitcnt lgkmcnt(8)
    v_mfma_f32_32x32x16_bf16 v[128:143], v[112:115], v[64:67], v[128:143]
    ds_read_b64_tr_b16 v[76:77], v7 offset:2688
    ds_read_b64_tr_b16 v[78:79], v7 offset:2720
    s_waitcnt lgkmcnt(8)
    v_mfma_f32_32x32x16_bf16 v[144:159], v[80:83], v[64:67], v[144:159]
    ds_read_b64_tr_b16 v[88:89], v7 offset:3200
    ds_read_b64_tr_b16 v[90:91], v7 offset:3232
    s_waitcnt lgkmcnt(8)
    v_mfma_f32_32x32x16_bf16 v[160:175], v[84:87], v[64:67], v[160:175]
    ds_read_b64_tr_b16 v[120:121], v7 offset:3712
    ds_read_b64_tr_b16 v[122:123], v7 offset:3744
    s_waitcnt lgkmcnt(8)
    v_mfma_f32_32x32x16_bf16 v[176:191], v[116:119], v[64:67], v[176:191]
    ds_read_b64_tr_b16 v[104:105], v6 offset:800
    ds_read_b64_tr_b16 v[106:107], v6 offset:768
    s_waitcnt lgkmcnt(8)
    v_mfma_f32_32x32x16_bf16 v[192:207], v[108:111], v[64:67], v[192:207]
    ds_read_b64_tr_b16 v[72:73], v6 offset:1312
    ds_read_b64_tr_b16 v[74:75], v6 offset:1280
    s_waitcnt lgkmcnt(8)
    v_mfma_f32_32x32x16_bf16 v[208:223], v[76:79], v[64:67], v[208:223]
    ds_read_b64_tr_b16 v[92:93], v6 offset:1824
    ds_read_b64_tr_b16 v[94:95], v6 offset:1792
    s_waitcnt lgkmcnt(8)
    v_mfma_f32_32x32x16_bf16 v[224:239], v[88:91], v[64:67], v[224:239]
    ds_read_b64_tr_b16 v[124:125], v6 offset:2336
    ds_read_b64_tr_b16 v[126:127], v6 offset:2304
    s_waitcnt lgkmcnt(8)
    v_mfma_f32_32x32x16_bf16 v[240:255], v[120:123], v[64:67], v[240:255]
    ds_read_b64_tr_b16 v[100:101], v6 offset:2848
    ds_read_b64_tr_b16 v[102:103], v6 offset:2816
    s_waitcnt lgkmcnt(8)
    v_mfma_f32_32x32x16_bf16 v[144:159], v[112:115], v[104:107], v[144:159]
    ds_read_b64_tr_b16 v[68:69], v6 offset:3360
    ds_read_b64_tr_b16 v[70:71], v6 offset:3328
    v_mfma_f32_32x32x16_bf16 v[160:175], v[80:83], v[104:107], v[160:175]
    ds_read_b64_tr_b16 v[96:97], v6 offset:3872
    ds_read_b64_tr_b16 v[98:99], v6 offset:3840
    v_mfma_f32_32x32x16_bf16 v[176:191], v[84:87], v[104:107], v[176:191]
    v_mfma_f32_32x32x16_bf16 v[192:207], v[116:119], v[104:107], v[192:207]
    v_mfma_f32_32x32x16_bf16 v[208:223], v[108:111], v[104:107], v[208:223]
    v_mfma_f32_32x32x16_bf16 v[224:239], v[76:79], v[104:107], v[224:239]
    v_mfma_f32_32x32x16_bf16 v[240:255], v[88:91], v[104:107], v[240:255]
    s_waitcnt lgkmcnt(10)
    v_mfma_f32_32x32x16_bf16 v[160:175], v[112:115], v[72:75], v[160:175]
    ds_read_b64_tr_b16 v[64:65], v6 offset:416
    ds_read_b64_tr_b16 v[66:67], v6 offset:384
    v_mfma_f32_32x32x16_bf16 v[176:191], v[80:83], v[72:75], v[176:191]
    v_mfma_f32_32x32x16_bf16 v[192:207], v[84:87], v[72:75], v[192:207]
    v_mfma_f32_32x32x16_bf16 v[208:223], v[116:119], v[72:75], v[208:223]
    v_mfma_f32_32x32x16_bf16 v[224:239], v[108:111], v[72:75], v[224:239]
    v_mfma_f32_32x32x16_bf16 v[240:255], v[76:79], v[72:75], v[240:255]
    s_waitcnt lgkmcnt(10)
    v_mfma_f32_32x32x16_bf16 v[176:191], v[112:115], v[92:95], v[176:191]
    ds_read_b64_tr_b16 v[120:121], v7 offset:0
    ds_read_b64_tr_b16 v[122:123], v7 offset:32
    v_mfma_f32_32x32x16_bf16 v[192:207], v[80:83], v[92:95], v[192:207]
    v_mfma_f32_32x32x16_bf16 v[208:223], v[84:87], v[92:95], v[208:223]
    v_mfma_f32_32x32x16_bf16 v[224:239], v[116:119], v[92:95], v[224:239]
    v_mfma_f32_32x32x16_bf16 v[240:255], v[108:111], v[92:95], v[240:255]
    s_waitcnt lgkmcnt(10)
    v_mfma_f32_32x32x16_bf16 v[192:207], v[112:115], v[124:127], v[192:207]
    ds_read_b64_tr_b16 v[104:105], v7 offset:512
    ds_read_b64_tr_b16 v[106:107], v7 offset:544
    v_mfma_f32_32x32x16_bf16 v[208:223], v[80:83], v[124:127], v[208:223]
    v_mfma_f32_32x32x16_bf16 v[224:239], v[84:87], v[124:127], v[224:239]
    v_mfma_f32_32x32x16_bf16 v[240:255], v[116:119], v[124:127], v[240:255]
    s_waitcnt lgkmcnt(10)
    v_mfma_f32_32x32x16_bf16 v[208:223], v[112:115], v[100:103], v[208:223]
    ds_read_b64_tr_b16 v[88:89], v6 offset:928
    ds_read_b64_tr_b16 v[90:91], v6 offset:896
    v_mfma_f32_32x32x16_bf16 v[224:239], v[80:83], v[100:103], v[224:239]
    v_mfma_f32_32x32x16_bf16 v[240:255], v[84:87], v[100:103], v[240:255]
    s_waitcnt lgkmcnt(10)
    v_mfma_f32_32x32x16_bf16 v[224:239], v[112:115], v[68:71], v[224:239]
    ds_read_b64_tr_b16 v[72:73], v7 offset:1024
    ds_read_b64_tr_b16 v[74:75], v7 offset:1056
    v_mfma_f32_32x32x16_bf16 v[240:255], v[80:83], v[68:71], v[240:255]
    s_waitcnt lgkmcnt(10)
    v_mfma_f32_32x32x16_bf16 v[240:255], v[112:115], v[96:99], v[240:255]
    ds_read_b64_tr_b16 v[76:77], v6 offset:1440
    ds_read_b64_tr_b16 v[78:79], v6 offset:1408
    s_waitcnt lgkmcnt(8)
    v_mfma_f32_32x32x16_bf16 v[128:143], v[120:123], v[64:67], v[128:143]
    ds_read_b64_tr_b16 v[92:93], v7 offset:1536
    ds_read_b64_tr_b16 v[94:95], v7 offset:1568
    s_waitcnt lgkmcnt(8)
    v_mfma_f32_32x32x16_bf16 v[144:159], v[104:107], v[64:67], v[144:159]
    ds_read_b64_tr_b16 v[108:109], v6 offset:1952
    ds_read_b64_tr_b16 v[110:111], v6 offset:1920
    s_waitcnt lgkmcnt(8)
    v_mfma_f32_32x32x16_bf16 v[144:159], v[120:123], v[88:91], v[144:159]
    ds_read_b64_tr_b16 v[124:125], v7 offset:2048
    ds_read_b64_tr_b16 v[126:127], v7 offset:2080
    s_waitcnt lgkmcnt(8)
    v_mfma_f32_32x32x16_bf16 v[160:175], v[72:75], v[64:67], v[160:175]
    ds_read_b64_tr_b16 v[116:117], v6 offset:2464
    ds_read_b64_tr_b16 v[118:119], v6 offset:2432
    v_nop
    v_cndmask_b32 v9, v135, v131, s[58:59]
    v_cndmask_b32 v10, v139, v135, s[58:59]
    v_cndmask_b32 v11, v143, v139, s[58:59]
    v_mfma_f32_32x32x16_bf16 v[160:175], v[104:107], v[88:91], v[160:175]
    ds_read_b64_tr_b16 v[100:101], v7 offset:2560
    ds_read_b64_tr_b16 v[102:103], v7 offset:2592
    v_add_f32_dpp v130, v131, v130 wave_shr:1 row_mask:0xf bank_mask:0xf bound_ctrl:0
    v_add_f32_dpp v134, v9, v134 wave_ror:1 row_mask:0xf bank_mask:0xf
    v_add_f32_dpp v138, v10, v138 wave_ror:1 row_mask:0xf bank_mask:0xf
    v_add_f32_dpp v142, v11, v142 wave_ror:1 row_mask:0xf bank_mask:0xf
    s_waitcnt lgkmcnt(10)
    v_mfma_f32_32x32x16_bf16 v[160:175], v[120:123], v[76:79], v[160:175]
    ds_read_b64_tr_b16 v[84:85], v6 offset:2976
    ds_read_b64_tr_b16 v[86:87], v6 offset:2944
    v_nop
    v_cndmask_b32 v9, v134, v130, s[58:59]
    v_cndmask_b32 v10, v138, v134, s[58:59]
    v_cndmask_b32 v11, v142, v138, s[58:59]
    s_waitcnt lgkmcnt(10)
    v_mfma_f32_32x32x16_bf16 v[176:191], v[92:95], v[64:67], v[176:191]
    ds_read_b64_tr_b16 v[68:69], v7 offset:3072
    ds_read_b64_tr_b16 v[70:71], v7 offset:3104
    v_add_f32_dpp v129, v130, v129 wave_shr:1 row_mask:0xf bank_mask:0xf bound_ctrl:0
    v_add_f32_dpp v133, v9, v133 wave_ror:1 row_mask:0xf bank_mask:0xf
    v_add_f32_dpp v137, v10, v137 wave_ror:1 row_mask:0xf bank_mask:0xf
    v_add_f32_dpp v141, v11, v141 wave_ror:1 row_mask:0xf bank_mask:0xf
    v_mfma_f32_32x32x16_bf16 v[176:191], v[72:75], v[88:91], v[176:191]
    v_nop
    v_cndmask_b32 v9, v133, v129, s[58:59]
    v_cndmask_b32 v10, v137, v133, s[58:59]
    v_cndmask_b32 v11, v141, v137, s[58:59]
    v_add_f32_dpp v128, v129, v128 wave_shr:1 row_mask:0xf bank_mask:0xf bound_ctrl:0
    v_add_f32_dpp v132, v9, v132 wave_ror:1 row_mask:0xf bank_mask:0xf
    v_mfma_f32_32x32x16_bf16 v[176:191], v[104:107], v[76:79], v[176:191]
    v_add_f32_dpp v136, v10, v136 wave_ror:1 row_mask:0xf bank_mask:0xf
    v_add_f32_dpp v140, v11, v140 wave_ror:1 row_mask:0xf bank_mask:0xf
    v_cvt_pk_bf16_f32 v12, v128, v132
    v_cvt_pk_bf16_f32 v13, v136, v140
    ds_write_b64 v4, v[12:13] offset:0
    v_cndmask_b32 v8, v147, v143, s[58:59]
    s_waitcnt lgkmcnt(11)
    v_mfma_f32_32x32x16_bf16 v[176:191], v[120:123], v[108:111], v[176:191]
    ds_read_b64_tr_b16 v[80:81], v6 offset:3488
    ds_read_b64_tr_b16 v[82:83], v6 offset:3456
    v_cndmask_b32 v9, v151, v147, s[58:59]
    v_cndmask_b32 v10, v155, v151, s[58:59]
    v_cndmask_b32 v11, v159, v155, s[58:59]
    v_add_f32_dpp v146, v8, v146 wave_ror:1 row_mask:0xf bank_mask:0xf
    s_waitcnt lgkmcnt(11)
    v_mfma_f32_32x32x16_bf16 v[192:207], v[124:127], v[64:67], v[192:207]
    ds_read_b64_tr_b16 v[96:97], v7 offset:3584
    ds_read_b64_tr_b16 v[98:99], v7 offset:3616
    v_add_f32_dpp v150, v9, v150 wave_ror:1 row_mask:0xf bank_mask:0xf
    v_add_f32_dpp v154, v10, v154 wave_ror:1 row_mask:0xf bank_mask:0xf
    v_add_f32_dpp v158, v11, v158 wave_ror:1 row_mask:0xf bank_mask:0xf
    v_cndmask_b32 v8, v146, v142, s[58:59]
    v_mfma_f32_32x32x16_bf16 v[192:207], v[92:95], v[88:91], v[192:207]
    v_cndmask_b32 v9, v150, v146, s[58:59]
    v_cndmask_b32 v10, v154, v150, s[58:59]
    v_cndmask_b32 v11, v158, v154, s[58:59]
    v_add_f32_dpp v145, v8, v145 wave_ror:1 row_mask:0xf bank_mask:0xf
    v_add_f32_dpp v149, v9, v149 wave_ror:1 row_mask:0xf bank_mask:0xf
    v_add_f32_dpp v153, v10, v153 wave_ror:1 row_mask:0xf bank_mask:0xf
    v_mfma_f32_32x32x16_bf16 v[192:207], v[72:75], v[76:79], v[192:207]
    v_add_f32_dpp v157, v11, v157 wave_ror:1 row_mask:0xf bank_mask:0xf
    v_cndmask_b32 v8, v145, v141, s[58:59]
    v_cndmask_b32 v9, v149, v145, s[58:59]
    v_cndmask_b32 v10, v153, v149, s[58:59]
    v_cndmask_b32 v11, v157, v153, s[58:59]
    v_add_f32_dpp v144, v8, v144 wave_ror:1 row_mask:0xf bank_mask:0xf
    v_mfma_f32_32x32x16_bf16 v[192:207], v[104:107], v[108:111], v[192:207]
    v_add_f32_dpp v148, v9, v148 wave_ror:1 row_mask:0xf bank_mask:0xf
    v_add_f32_dpp v152, v10, v152 wave_ror:1 row_mask:0xf bank_mask:0xf
    v_add_f32_dpp v156, v11, v156 wave_ror:1 row_mask:0xf bank_mask:0xf
    v_cvt_pk_bf16_f32 v14, v144, v148
    v_cvt_pk_bf16_f32 v15, v152, v156
    ds_write_b64 v4, v[14:15] offset:512
    s_waitcnt lgkmcnt(12)
    v_mfma_f32_32x32x16_bf16 v[192:207], v[120:123], v[116:119], v[192:207]
    v_cndmask_b32 v8, v163, v159, s[58:59]
    v_cndmask_b32 v9, v167, v163, s[58:59]
    v_cndmask_b32 v10, v171, v167, s[58:59]
    v_cndmask_b32 v11, v175, v171, s[58:59]
    v_add_f32_dpp v162, v8, v162 wave_ror:1 row_mask:0xf bank_mask:0xf
    v_add_f32_dpp v166, v9, v166 wave_ror:1 row_mask:0xf bank_mask:0xf
    s_waitcnt lgkmcnt(10)
    v_mfma_f32_32x32x16_bf16 v[208:223], v[100:103], v[64:67], v[208:223]
    ds_read_b64_tr_b16 v[112:113], v6 offset:4000
    ds_read_b64_tr_b16 v[114:115], v6 offset:3968
    v_add_f32_dpp v170, v10, v170 wave_ror:1 row_mask:0xf bank_mask:0xf
    v_add_f32_dpp v174, v11, v174 wave_ror:1 row_mask:0xf bank_mask:0xf
    v_cndmask_b32 v8, v162, v158, s[58:59]
    v_cndmask_b32 v9, v166, v162, s[58:59]
    v_mfma_f32_32x32x16_bf16 v[208:223], v[124:127], v[88:91], v[208:223]
    v_cndmask_b32 v10, v170, v166, s[58:59]
    v_cndmask_b32 v11, v174, v170, s[58:59]
    v_add_f32_dpp v161, v8, v161 wave_ror:1 row_mask:0xf bank_mask:0xf
    v_add_f32_dpp v165, v9, v165 wave_ror:1 row_mask:0xf bank_mask:0xf
    v_add_f32_dpp v169, v10, v169 wave_ror:1 row_mask:0xf bank_mask:0xf
    v_add_f32_dpp v173, v11, v173 wave_ror:1 row_mask:0xf bank_mask:0xf
    v_mfma_f32_32x32x16_bf16 v[208:223], v[92:95], v[76:79], v[208:223]
    v_cndmask_b32 v8, v161, v157, s[58:59]
    v_cndmask_b32 v9, v165, v161, s[58:59]
    v_cndmask_b32 v10, v169, v165, s[58:59]
    v_cndmask_b32 v11, v173, v169, s[58:59]
    v_add_f32_dpp v160, v8, v160 wave_ror:1 row_mask:0xf bank_mask:0xf
    v_add_f32_dpp v164, v9, v164 wave_ror:1 row_mask:0xf bank_mask:0xf
    v_mfma_f32_32x32x16_bf16 v[208:223], v[72:75], v[108:111], v[208:223]
    v_add_f32_dpp v168, v10, v168 wave_ror:1 row_mask:0xf bank_mask:0xf
    v_add_f32_dpp v172, v11, v172 wave_ror:1 row_mask:0xf bank_mask:0xf
    v_cvt_pk_bf16_f32 v12, v160, v164
    v_cvt_pk_bf16_f32 v13, v168, v172
    ds_write_b64 v4, v[12:13] offset:1024
    v_cndmask_b32 v8, v179, v175, s[58:59]
    v_mfma_f32_32x32x16_bf16 v[208:223], v[104:107], v[116:119], v[208:223]
    v_cndmask_b32 v9, v183, v179, s[58:59]
    v_cndmask_b32 v10, v187, v183, s[58:59]
    v_cndmask_b32 v11, v191, v187, s[58:59]
    v_add_f32_dpp v178, v8, v178 wave_ror:1 row_mask:0xf bank_mask:0xf
    v_add_f32_dpp v182, v9, v182 wave_ror:1 row_mask:0xf bank_mask:0xf
    v_add_f32_dpp v186, v10, v186 wave_ror:1 row_mask:0xf bank_mask:0xf
    s_waitcnt lgkmcnt(11)
    v_mfma_f32_32x32x16_bf16 v[208:223], v[120:123], v[84:87], v[208:223]
    v_add_f32_dpp v190, v11, v190 wave_ror:1 row_mask:0xf bank_mask:0xf
    v_cndmask_b32 v8, v178, v174, s[58:59]
    v_cndmask_b32 v9, v182, v178, s[58:59]
    v_cndmask_b32 v10, v186, v182, s[58:59]
    v_cndmask_b32 v11, v190, v186, s[58:59]
    v_add_f32_dpp v177, v8, v177 wave_ror:1 row_mask:0xf bank_mask:0xf
    s_waitcnt lgkmcnt(9)
    v_mfma_f32_32x32x16_bf16 v[224:239], v[68:71], v[64:67], v[224:239]
    v_add_f32_dpp v181, v9, v181 wave_ror:1 row_mask:0xf bank_mask:0xf
    v_add_f32_dpp v185, v10, v185 wave_ror:1 row_mask:0xf bank_mask:0xf
    v_add_f32_dpp v189, v11, v189 wave_ror:1 row_mask:0xf bank_mask:0xf
    v_cndmask_b32 v8, v177, v173, s[58:59]
    v_cndmask_b32 v9, v181, v177, s[58:59]
    v_cndmask_b32 v10, v185, v181, s[58:59]
    v_mfma_f32_32x32x16_bf16 v[224:239], v[100:103], v[88:91], v[224:239]
    v_cndmask_b32 v11, v189, v185, s[58:59]
    v_add_f32_dpp v176, v8, v176 wave_ror:1 row_mask:0xf bank_mask:0xf
    v_add_f32_dpp v180, v9, v180 wave_ror:1 row_mask:0xf bank_mask:0xf
    v_add_f32_dpp v184, v10, v184 wave_ror:1 row_mask:0xf bank_mask:0xf
    v_add_f32_dpp v188, v11, v188 wave_ror:1 row_mask:0xf bank_mask:0xf
    v_cvt_pk_bf16_f32 v14, v176, v180
    v_mfma_f32_32x32x16_bf16 v[224:239], v[124:127], v[76:79], v[224:239]
    v_cvt_pk_bf16_f32 v15, v184, v188
    ds_write_b64 v4, v[14:15] offset:1536
    v_cndmask_b32 v8, v195, v191, s[58:59]
    v_cndmask_b32 v9, v199, v195, s[58:59]
    v_cndmask_b32 v10, v203, v199, s[58:59]
    v_cndmask_b32 v11, v207, v203, s[58:59]
    v_mfma_f32_32x32x16_bf16 v[224:239], v[92:95], v[108:111], v[224:239]
    v_add_f32_dpp v194, v8, v194 wave_ror:1 row_mask:0xf bank_mask:0xf
    v_add_f32_dpp v198, v9, v198 wave_ror:1 row_mask:0xf bank_mask:0xf
    v_add_f32_dpp v202, v10, v202 wave_ror:1 row_mask:0xf bank_mask:0xf
    v_add_f32_dpp v206, v11, v206 wave_ror:1 row_mask:0xf bank_mask:0xf
    v_cndmask_b32 v8, v194, v190, s[58:59]
    v_cndmask_b32 v9, v198, v194, s[58:59]
    v_mfma_f32_32x32x16_bf16 v[224:239], v[72:75], v[116:119], v[224:239]
    v_cndmask_b32 v10, v202, v198, s[58:59]
    v_cndmask_b32 v11, v206, v202, s[58:59]
    v_add_f32_dpp v193, v8, v193 wave_ror:1 row_mask:0xf bank_mask:0xf
    v_add_f32_dpp v197, v9, v197 wave_ror:1 row_mask:0xf bank_mask:0xf
    v_add_f32_dpp v201, v10, v201 wave_ror:1 row_mask:0xf bank_mask:0xf
    v_add_f32_dpp v205, v11, v205 wave_ror:1 row_mask:0xf bank_mask:0xf
    v_mfma_f32_32x32x16_bf16 v[224:239], v[104:107], v[84:87], v[224:239]
    v_cndmask_b32 v8, v193, v189, s[58:59]
    v_cndmask_b32 v9, v197, v193, s[58:59]
    v_cndmask_b32 v10, v201, v197, s[58:59]
    v_cndmask_b32 v11, v205, v201, s[58:59]
    v_add_f32_dpp v192, v8, v192 wave_ror:1 row_mask:0xf bank_mask:0xf
    v_add_f32_dpp v196, v9, v196 wave_ror:1 row_mask:0xf bank_mask:0xf
    s_waitcnt lgkmcnt(7)
    v_mfma_f32_32x32x16_bf16 v[224:239], v[120:123], v[80:83], v[224:239]
    v_add_f32_dpp v200, v10, v200 wave_ror:1 row_mask:0xf bank_mask:0xf
    v_add_f32_dpp v204, v11, v204 wave_ror:1 row_mask:0xf bank_mask:0xf
    v_cvt_pk_bf16_f32 v12, v192, v196
    v_cvt_pk_bf16_f32 v13, v200, v204
    ds_write_b64 v4, v[12:13] offset:2048
    v_cndmask_b32 v8, v211, v207, s[58:59]
    s_waitcnt lgkmcnt(6)
    v_mfma_f32_32x32x16_bf16 v[240:255], v[96:99], v[64:67], v[240:255]
    v_cndmask_b32 v9, v215, v211, s[58:59]
    v_cndmask_b32 v10, v219, v215, s[58:59]
    v_cndmask_b32 v11, v223, v219, s[58:59]
    v_add_f32_dpp v210, v8, v210 wave_ror:1 row_mask:0xf bank_mask:0xf
    v_add_f32_dpp v214, v9, v214 wave_ror:1 row_mask:0xf bank_mask:0xf
    v_add_f32_dpp v218, v10, v218 wave_ror:1 row_mask:0xf bank_mask:0xf
    v_mfma_f32_32x32x16_bf16 v[240:255], v[68:71], v[88:91], v[240:255]
    v_add_f32_dpp v222, v11, v222 wave_ror:1 row_mask:0xf bank_mask:0xf
    v_cndmask_b32 v8, v210, v206, s[58:59]
    v_cndmask_b32 v9, v214, v210, s[58:59]
    v_cndmask_b32 v10, v218, v214, s[58:59]
    v_cndmask_b32 v11, v222, v218, s[58:59]
    v_add_f32_dpp v209, v8, v209 wave_ror:1 row_mask:0xf bank_mask:0xf
    v_mfma_f32_32x32x16_bf16 v[240:255], v[100:103], v[76:79], v[240:255]
    v_add_f32_dpp v213, v9, v213 wave_ror:1 row_mask:0xf bank_mask:0xf
    v_add_f32_dpp v217, v10, v217 wave_ror:1 row_mask:0xf bank_mask:0xf
    v_add_f32_dpp v221, v11, v221 wave_ror:1 row_mask:0xf bank_mask:0xf
    v_cndmask_b32 v8, v209, v205, s[58:59]
    v_cndmask_b32 v9, v213, v209, s[58:59]
    v_cndmask_b32 v10, v217, v213, s[58:59]
    v_mfma_f32_32x32x16_bf16 v[240:255], v[124:127], v[108:111], v[240:255]
    v_cndmask_b32 v11, v221, v217, s[58:59]
    v_add_f32_dpp v208, v8, v208 wave_ror:1 row_mask:0xf bank_mask:0xf
    v_add_f32_dpp v212, v9, v212 wave_ror:1 row_mask:0xf bank_mask:0xf
    v_add_f32_dpp v216, v10, v216 wave_ror:1 row_mask:0xf bank_mask:0xf
    v_add_f32_dpp v220, v11, v220 wave_ror:1 row_mask:0xf bank_mask:0xf
    v_cvt_pk_bf16_f32 v14, v208, v212
    v_mfma_f32_32x32x16_bf16 v[240:255], v[92:95], v[116:119], v[240:255]
    v_cvt_pk_bf16_f32 v15, v216, v220
    ds_write_b64 v4, v[14:15] offset:2560
    v_cndmask_b32 v8, v227, v223, s[58:59]
    v_cndmask_b32 v9, v231, v227, s[58:59]
    v_cndmask_b32 v10, v235, v231, s[58:59]
    v_cndmask_b32 v11, v239, v235, s[58:59]
    v_mfma_f32_32x32x16_bf16 v[240:255], v[72:75], v[84:87], v[240:255]
    v_add_f32_dpp v226, v8, v226 wave_ror:1 row_mask:0xf bank_mask:0xf
    v_add_f32_dpp v230, v9, v230 wave_ror:1 row_mask:0xf bank_mask:0xf
    v_add_f32_dpp v234, v10, v234 wave_ror:1 row_mask:0xf bank_mask:0xf
    v_add_f32_dpp v238, v11, v238 wave_ror:1 row_mask:0xf bank_mask:0xf
    v_cndmask_b32 v8, v226, v222, s[58:59]
    v_cndmask_b32 v9, v230, v226, s[58:59]
    v_mfma_f32_32x32x16_bf16 v[240:255], v[104:107], v[80:83], v[240:255]
    v_cndmask_b32 v10, v234, v230, s[58:59]
    v_cndmask_b32 v11, v238, v234, s[58:59]
    v_add_f32_dpp v225, v8, v225 wave_ror:1 row_mask:0xf bank_mask:0xf
    v_add_f32_dpp v229, v9, v229 wave_ror:1 row_mask:0xf bank_mask:0xf
    v_add_f32_dpp v233, v10, v233 wave_ror:1 row_mask:0xf bank_mask:0xf
    v_add_f32_dpp v237, v11, v237 wave_ror:1 row_mask:0xf bank_mask:0xf
    s_waitcnt lgkmcnt(4)
    v_mfma_f32_32x32x16_bf16 v[240:255], v[120:123], v[112:115], v[240:255]
    v_cndmask_b32 v8, v225, v221, s[58:59]
    v_cndmask_b32 v9, v229, v225, s[58:59]
    v_cndmask_b32 v10, v233, v229, s[58:59]
    v_cndmask_b32 v11, v237, v233, s[58:59]
    v_add_f32_dpp v224, v8, v224 wave_ror:1 row_mask:0xf bank_mask:0xf
    v_add_f32_dpp v228, v9, v228 wave_ror:1 row_mask:0xf bank_mask:0xf
    v_add_f32_dpp v232, v10, v232 wave_ror:1 row_mask:0xf bank_mask:0xf
    v_add_f32_dpp v236, v11, v236 wave_ror:1 row_mask:0xf bank_mask:0xf
    v_cvt_pk_bf16_f32 v12, v224, v228
    v_cvt_pk_bf16_f32 v13, v232, v236
    ds_write_b64 v4, v[12:13] offset:3072
    s_nop 0
    s_nop 0
    v_cndmask_b32 v8, v243, v239, s[58:59]
    v_cndmask_b32 v9, v247, v243, s[58:59]
    v_cndmask_b32 v10, v251, v247, s[58:59]
    v_cndmask_b32 v11, v255, v251, s[58:59]
    v_add_f32_dpp v242, v8, v242 wave_ror:1 row_mask:0xf bank_mask:0xf
    v_add_f32_dpp v246, v9, v246 wave_ror:1 row_mask:0xf bank_mask:0xf
    v_add_f32_dpp v250, v10, v250 wave_ror:1 row_mask:0xf bank_mask:0xf
    v_add_f32_dpp v254, v11, v254 wave_ror:1 row_mask:0xf bank_mask:0xf
    v_cndmask_b32 v8, v242, v238, s[58:59]
    v_cndmask_b32 v9, v246, v242, s[58:59]
    v_cndmask_b32 v10, v250, v246, s[58:59]
    v_cndmask_b32 v11, v254, v250, s[58:59]
    v_add_f32_dpp v241, v8, v241 wave_ror:1 row_mask:0xf bank_mask:0xf
    v_add_f32_dpp v245, v9, v245 wave_ror:1 row_mask:0xf bank_mask:0xf
    v_add_f32_dpp v249, v10, v249 wave_ror:1 row_mask:0xf bank_mask:0xf
    v_add_f32_dpp v253, v11, v253 wave_ror:1 row_mask:0xf bank_mask:0xf
    v_cndmask_b32 v8, v241, v237, s[58:59]
    v_cndmask_b32 v9, v245, v241, s[58:59]
    v_cndmask_b32 v10, v249, v245, s[58:59]
    v_cndmask_b32 v11, v253, v249, s[58:59]
    v_add_f32_dpp v240, v8, v240 wave_ror:1 row_mask:0xf bank_mask:0xf
    v_add_f32_dpp v244, v9, v244 wave_ror:1 row_mask:0xf bank_mask:0xf
    v_add_f32_dpp v248, v10, v248 wave_ror:1 row_mask:0xf bank_mask:0xf
    v_add_f32_dpp v252, v11, v252 wave_ror:1 row_mask:0xf bank_mask:0xf
    v_cvt_pk_bf16_f32 v14, v240, v244
    v_cvt_pk_bf16_f32 v15, v248, v252
    ds_write_b64 v4, v[14:15] offset:3584
    v_lshlrev_b32 v5, 4, v0
    s_waitcnt lgkmcnt(0)
    s_barrier
    ds_read_b128 v[64:67], v5 offset:35328
    ds_read_b128 v[68:71], v5 offset:39424
    ds_read_b128 v[72:75], v5 offset:43520
    ds_read_b128 v[76:79], v5 offset:47616
    s_waitcnt lgkmcnt(0)
    v_lshlrev_b32 v8, 16, v32
    v_lshlrev_b32 v12, 16, v64
    v_lshlrev_b32 v10, 16, v16
    v_fmac_f32 v12, s38, v8
    v_lshlrev_b32 v8, 16, v33
    v_lshlrev_b32 v13, 16, v68
    v_and_b32 v11, 0xffff0000, v16
    v_fmac_f32 v13, s39, v8
    v_pk_fma_f32 v[10:11], v[12:13], v[56:57], v[10:11]
    v_cvt_pk_bf16_f32 v96, v10, v11
    v_lshlrev_b32 v8, 16, v34
    v_lshlrev_b32 v12, 16, v72
    v_lshlrev_b32 v10, 16, v17
    v_fmac_f32 v12, s36, v8
    v_lshlrev_b32 v8, 16, v35
    v_lshlrev_b32 v13, 16, v76
    v_and_b32 v11, 0xffff0000, v17
    v_fmac_f32 v13, s37, v8
    v_pk_fma_f32 v[10:11], v[12:13], v[58:59], v[10:11]
    v_cvt_pk_bf16_f32 v97, v10, v11
    v_and_b32 v8, 0xffff0000, v32
    v_lshlrev_b32 v12, 16, v66
    v_lshlrev_b32 v10, 16, v18
    v_fmac_f32 v12, s38, v8
    v_and_b32 v8, 0xffff0000, v33
    v_lshlrev_b32 v13, 16, v70
    v_and_b32 v11, 0xffff0000, v18
    v_fmac_f32 v13, s39, v8
    v_pk_fma_f32 v[10:11], v[12:13], v[56:57], v[10:11]
    v_cvt_pk_bf16_f32 v98, v10, v11
    v_and_b32 v8, 0xffff0000, v34
    v_lshlrev_b32 v12, 16, v74
    v_lshlrev_b32 v10, 16, v19
    v_fmac_f32 v12, s36, v8
    v_and_b32 v8, 0xffff0000, v35
    v_lshlrev_b32 v13, 16, v78
    v_and_b32 v11, 0xffff0000, v19
    v_fmac_f32 v13, s37, v8
    v_pk_fma_f32 v[10:11], v[12:13], v[58:59], v[10:11]
    v_cvt_pk_bf16_f32 v99, v10, v11
    buffer_store_dwordx4 v[96:99], v3, s[52:55], s24 offen offset:0 sc1
    v_lshlrev_b32 v8, 16, v36
    v_and_b32 v12, 0xffff0000, v64
    v_lshlrev_b32 v10, 16, v20
    v_fmac_f32 v12, s38, v8
    v_lshlrev_b32 v8, 16, v37
    v_and_b32 v13, 0xffff0000, v68
    v_and_b32 v11, 0xffff0000, v20
    v_fmac_f32 v13, s39, v8
    v_pk_fma_f32 v[10:11], v[12:13], v[56:57], v[10:11]
    v_cvt_pk_bf16_f32 v100, v10, v11
    v_lshlrev_b32 v8, 16, v38
    v_and_b32 v12, 0xffff0000, v72
    v_lshlrev_b32 v10, 16, v21
    v_fmac_f32 v12, s36, v8
    v_lshlrev_b32 v8, 16, v39
    v_and_b32 v13, 0xffff0000, v76
    v_and_b32 v11, 0xffff0000, v21
    v_fmac_f32 v13, s37, v8
    v_pk_fma_f32 v[10:11], v[12:13], v[58:59], v[10:11]
    v_cvt_pk_bf16_f32 v101, v10, v11
    v_and_b32 v8, 0xffff0000, v36
    v_and_b32 v12, 0xffff0000, v66
    v_lshlrev_b32 v10, 16, v22
    v_fmac_f32 v12, s38, v8
    v_and_b32 v8, 0xffff0000, v37
    v_and_b32 v13, 0xffff0000, v70
    v_and_b32 v11, 0xffff0000, v22
    v_fmac_f32 v13, s39, v8
    v_pk_fma_f32 v[10:11], v[12:13], v[56:57], v[10:11]
    v_cvt_pk_bf16_f32 v102, v10, v11
    v_and_b32 v8, 0xffff0000, v38
    v_and_b32 v12, 0xffff0000, v74
    v_lshlrev_b32 v10, 16, v23
    v_fmac_f32 v12, s36, v8
    v_and_b32 v8, 0xffff0000, v39
    v_and_b32 v13, 0xffff0000, v78
    v_and_b32 v11, 0xffff0000, v23
    v_fmac_f32 v13, s37, v8
    v_pk_fma_f32 v[10:11], v[12:13], v[58:59], v[10:11]
    v_cvt_pk_bf16_f32 v103, v10, v11
    buffer_store_dwordx4 v[100:103], v3, s[52:55], s24 offen offset:512 sc1
    v_lshlrev_b32 v8, 16, v40
    v_lshlrev_b32 v12, 16, v65
    v_lshlrev_b32 v10, 16, v24
    v_fmac_f32 v12, s38, v8
    v_lshlrev_b32 v8, 16, v41
    v_lshlrev_b32 v13, 16, v69
    v_and_b32 v11, 0xffff0000, v24
    v_fmac_f32 v13, s39, v8
    v_pk_fma_f32 v[10:11], v[12:13], v[56:57], v[10:11]
    v_cvt_pk_bf16_f32 v104, v10, v11
    v_lshlrev_b32 v8, 16, v42
    v_lshlrev_b32 v12, 16, v73
    v_lshlrev_b32 v10, 16, v25
    v_fmac_f32 v12, s36, v8
    v_lshlrev_b32 v8, 16, v43
    v_lshlrev_b32 v13, 16, v77
    v_and_b32 v11, 0xffff0000, v25
    v_fmac_f32 v13, s37, v8
    v_pk_fma_f32 v[10:11], v[12:13], v[58:59], v[10:11]
    v_cvt_pk_bf16_f32 v105, v10, v11
    v_and_b32 v8, 0xffff0000, v40
    v_lshlrev_b32 v12, 16, v67
    v_lshlrev_b32 v10, 16, v26
    v_fmac_f32 v12, s38, v8
    v_and_b32 v8, 0xffff0000, v41
    v_lshlrev_b32 v13, 16, v71
    v_and_b32 v11, 0xffff0000, v26
    v_fmac_f32 v13, s39, v8
    v_pk_fma_f32 v[10:11], v[12:13], v[56:57], v[10:11]
    v_cvt_pk_bf16_f32 v106, v10, v11
    v_and_b32 v8, 0xffff0000, v42
    v_lshlrev_b32 v12, 16, v75
    v_lshlrev_b32 v10, 16, v27
    v_fmac_f32 v12, s36, v8
    v_and_b32 v8, 0xffff0000, v43
    v_lshlrev_b32 v13, 16, v79
    v_and_b32 v11, 0xffff0000, v27
    v_fmac_f32 v13, s37, v8
    v_pk_fma_f32 v[10:11], v[12:13], v[58:59], v[10:11]
    v_cvt_pk_bf16_f32 v107, v10, v11
    buffer_store_dwordx4 v[104:107], v3, s[52:55], s24 offen offset:1024 sc1
    v_lshlrev_b32 v8, 16, v44
    v_and_b32 v12, 0xffff0000, v65
    v_lshlrev_b32 v10, 16, v28
    v_fmac_f32 v12, s38, v8
    v_lshlrev_b32 v8, 16, v45
    v_and_b32 v13, 0xffff0000, v69
    v_and_b32 v11, 0xffff0000, v28
    v_fmac_f32 v13, s39, v8
    v_pk_fma_f32 v[10:11], v[12:13], v[56:57], v[10:11]
    v_cvt_pk_bf16_f32 v108, v10, v11
    v_lshlrev_b32 v8, 16, v46
    v_and_b32 v12, 0xffff0000, v73
    v_lshlrev_b32 v10, 16, v29
    v_fmac_f32 v12, s36, v8
    v_lshlrev_b32 v8, 16, v47
    v_and_b32 v13, 0xffff0000, v77
    v_and_b32 v11, 0xffff0000, v29
    v_fmac_f32 v13, s37, v8
    v_pk_fma_f32 v[10:11], v[12:13], v[58:59], v[10:11]
    v_cvt_pk_bf16_f32 v109, v10, v11
    v_and_b32 v8, 0xffff0000, v44
    v_and_b32 v12, 0xffff0000, v67
    v_lshlrev_b32 v10, 16, v30
    v_fmac_f32 v12, s38, v8
    v_and_b32 v8, 0xffff0000, v45
    v_and_b32 v13, 0xffff0000, v71
    v_and_b32 v11, 0xffff0000, v30
    v_fmac_f32 v13, s39, v8
    v_pk_fma_f32 v[10:11], v[12:13], v[56:57], v[10:11]
    v_cvt_pk_bf16_f32 v110, v10, v11
    v_and_b32 v8, 0xffff0000, v46
    v_and_b32 v12, 0xffff0000, v75
    v_lshlrev_b32 v10, 16, v31
    v_fmac_f32 v12, s36, v8
    v_and_b32 v8, 0xffff0000, v47
    v_and_b32 v13, 0xffff0000, v79
    v_and_b32 v11, 0xffff0000, v31
    v_fmac_f32 v13, s37, v8
    v_pk_fma_f32 v[10:11], v[12:13], v[58:59], v[10:11]
    v_cvt_pk_bf16_f32 v111, v10, v11
    buffer_store_dwordx4 v[108:111], v3, s[52:55], s24 offen offset:1536 sc1
    s_endpgm
f_prod:
    s_setprio 3
    s_cmp_ge_u32 s2, 128
    s_cbranch_scc1 f_mod
    s_load_dwordx2 s[8:9], s[0:1], 0
    s_lshl_b32 s3, s2, 4
    v_and_b32 v3, 7, v0
    v_lshrrev_b32 v4, 3, v0
    v_lshl_add_u32 v5, v3, 1, s3
    v_mul_u32_u24 v6, 1280, v5
    v_lshl_add_u32 v6, v4, 3, v6
    v_lshlrev_b32 v7, 14, v4
    v_lshl_add_u32 v7, v5, 3, v7
    s_waitcnt lgkmcnt(0)
    s_mov_b32 s10, 2621440
    s_mov_b32 s11, 0x00020000
    s_mov_b32 s30, 256
    s_mov_b32 s31, 0x00020000
    s_add_u32 s12, s4, 1048576
    s_addc_u32 s13, s5, 0
    s_mov_b32 s14, 2621440
    s_mov_b32 s15, 0x00020000
    s_add_u32 s16, s4, 65536
    s_addc_u32 s17, s5, 0
    s_mov_b32 s18, 16384
    s_mov_b32 s19, 0x00020000
    s_add_u32 s64, s4, 114688
    s_addc_u32 s65, s5, 0
    s_mov_b32 s66, 8192
    s_mov_b32 s67, 0x00020000
    s_or_b32 s61, s2, s32
    s_cbranch_scc1 f_z1
    v_mov_b32 v8, 0
    v_mov_b32 v9, 0
    v_mov_b32 v10, 0
    v_mov_b32 v11, 0
    v_lshlrev_b32 v12, 4, v1
    buffer_store_dwordx4 v[8:11], v12, s[64:67], 0 offen offset:0 sc1
    buffer_store_dwordx4 v[8:11], v12, s[64:67], 0 offen offset:1024 sc1
    buffer_store_dwordx4 v[8:11], v12, s[64:67], 0 offen offset:2048 sc1
    buffer_store_dwordx4 v[8:11], v12, s[64:67], 0 offen offset:3072 sc1
    s_movk_i32 s6, 4096
    buffer_store_dwordx4 v[8:11], v12, s[64:67], s6 offen offset:0 sc1
    buffer_store_dwordx4 v[8:11], v12, s[64:67], s6 offen offset:1024 sc1
    buffer_store_dwordx4 v[8:11], v12, s[64:67], s6 offen offset:2048 sc1
    buffer_store_dwordx4 v[8:11], v12, s[64:67], s6 offen offset:3072 sc1
f_z1:
    buffer_load_dwordx2 v[16:17], v6, s[8:11], 0 offen offset:0
    buffer_load_dwordx2 v[18:19], v6, s[8:11], 0 offen offset:1280
    buffer_load_dwordx2 v[20:21], v6, s[8:11], 0 offen offset:256
    buffer_load_dwordx2 v[22:23], v6, s[8:11], 0 offen offset:1536
    buffer_load_dwordx2 v[24:25], v6, s[8:11], 0 offen offset:512
    buffer_load_dwordx2 v[26:27], v6, s[8:11], 0 offen offset:1792
    buffer_load_dwordx2 v[28:29], v6, s[8:11], 0 offen offset:768
    buffer_load_dwordx2 v[30:31], v6, s[8:11], 0 offen offset:2048
    buffer_load_dwordx2 v[32:33], v6, s[8:11], 0 offen offset:1024
    buffer_load_dwordx2 v[34:35], v6, s[8:11], 0 offen offset:2304
    s_cmp_lg_u32 s61, 0
    s_cbranch_scc1 f_z2
    s_waitcnt vmcnt(10)
    v_mov_b32 v13, 0
    v_mov_b32 v14, 1
    s_mov_b64 exec, 1
    buffer_store_dword v14, v13, s[28:31], 0 offen sc1
    s_mov_b64 exec, -1
f_z2:
    v_mov_b32 v8, 0
    v_mov_b32 v9, 0
    v_mov_b32 v10, 0
    v_mov_b32 v11, 0
    v_mov_b32 v12, 0x3f803f80
    s_waitcnt vmcnt(8)
    s_mov_b32 s6, 0
    buffer_store_dwordx4 v[16:19], v7, s[12:15], s6 offen sc1
    v_dot2c_f32_bf16 v8, v12, v16
    v_dot2c_f32_bf16 v9, v16, v16
    v_dot2c_f32_bf16 v8, v12, v17
    v_dot2c_f32_bf16 v9, v17, v17
    v_dot2c_f32_bf16 v10, v12, v18
    v_dot2c_f32_bf16 v11, v18, v18
    v_dot2c_f32_bf16 v10, v12, v19
    v_dot2c_f32_bf16 v11, v19, v19
    s_waitcnt vmcnt(7)
    s_mov_b32 s6, 524288
    buffer_store_dwordx4 v[20:23], v7, s[12:15], s6 offen sc1
    v_dot2c_f32_bf16 v8, v12, v20
    v_dot2c_f32_bf16 v9, v20, v20
    v_dot2c_f32_bf16 v8, v12, v21
    v_dot2c_f32_bf16 v9, v21, v21
    v_dot2c_f32_bf16 v10, v12, v22
    v_dot2c_f32_bf16 v11, v22, v22
    v_dot2c_f32_bf16 v10, v12, v23
    v_dot2c_f32_bf16 v11, v23, v23
    s_waitcnt vmcnt(6)
    s_mov_b32 s6, 1048576
    buffer_store_dwordx4 v[24:27], v7, s[12:15], s6 offen sc1
    v_dot2c_f32_bf16 v8, v12, v24
    v_dot2c_f32_bf16 v9, v24, v24
    v_dot2c_f32_bf16 v8, v12, v25
    v_dot2c_f32_bf16 v9, v25, v25
    v_dot2c_f32_bf16 v10, v12, v26
    v_dot2c_f32_bf16 v11, v26, v26
    v_dot2c_f32_bf16 v10, v12, v27
    v_dot2c_f32_bf16 v11, v27, v27
    s_waitcnt vmcnt(5)
    s_mov_b32 s6, 1572864
    buffer_store_dwordx4 v[28:31], v7, s[12:15], s6 offen sc1
    v_dot2c_f32_bf16 v8, v12, v28
    v_dot2c_f32_bf16 v9, v28, v28
    v_dot2c_f32_bf16 v8, v12, v29
    v_dot2c_f32_bf16 v9, v29, v29
    v_dot2c_f32_bf16 v10, v12, v30
    v_dot2c_f32_bf16 v11, v30, v30
    v_dot2c_f32_bf16 v10, v12, v31
    v_dot2c_f32_bf16 v11, v31, v31
    s_waitcnt vmcnt(4)
    s_mov_b32 s6, 2097152
    buffer_store_dwordx4 v[32:35], v7, s[12:15], s6 offen sc1
    v_dot2c_f32_bf16 v8, v12, v32
    v_dot2c_f32_bf16 v9, v32, v32
    v_dot2c_f32_bf16 v8, v12, v33
    v_dot2c_f32_bf16 v9, v33, v33
    v_dot2c_f32_bf16 v10, v12, v34
    v_dot2c_f32_bf16 v11, v34, v34
    v_dot2c_f32_bf16 v10, v12, v35
    v_dot2c_f32_bf16 v11, v35, v35
    v_lshlrev_b32 v13, 4, v0
    s_nop 2
    ds_write_b128 v13, v[8:11]
    s_waitcnt lgkmcnt(0)
    s_barrier
    s_cmp_lg_u32 s32, 0
    s_cbranch_scc1 f_st2
    v_and_b32 v13, 15, v0
    v_lshlrev_b32 v13, 3, v13
    ds_read_b64 v[16:17], v13 offset:0
    ds_read_b64 v[18:19], v13 offset:128
    ds_read_b64 v[20:21], v13 offset:256
    ds_read_b64 v[22:23], v13 offset:384
    ds_read_b64 v[24:25], v13 offset:512
    ds_read_b64 v[26:27], v13 offset:640
    ds_read_b64 v[28:29], v13 offset:768
    ds_read_b64 v[30:31], v13 offset:896
    ds_read_b64 v[32:33], v13 offset:1024
    ds_read_b64 v[34:35], v13 offset:1152
    ds_read_b64 v[36:37], v13 offset:1280
    ds_read_b64 v[38:39], v13 offset:1408
    ds_read_b64 v[40:41], v13 offset:1536
    ds_read_b64 v[42:43], v13 offset:1664
    ds_read_b64 v[44:45], v13 offset:1792
    ds_read_b64 v[46:47], v13 offset:1920
    ds_read_b64 v[48:49], v13 offset:2048
    ds_read_b64 v[50:51], v13 offset:2176
    ds_read_b64 v[52:53], v13 offset:2304
    ds_read_b64 v[54:55], v13 offset:2432
    ds_read_b64 v[56:57], v13 offset:2560
    ds_read_b64 v[58:59], v13 offset:2688
    ds_read_b64 v[60:61], v13 offset:2816
    ds_read_b64 v[62:63], v13 offset:2944
    ds_read_b64 v[64:65], v13 offset:3072
    ds_read_b64 v[66:67], v13 offset:3200
    ds_read_b64 v[68:69], v13 offset:3328
    ds_read_b64 v[70:71], v13 offset:3456
    ds_read_b64 v[72:73], v13 offset:3584
    ds_read_b64 v[74:75], v13 offset:3712
    ds_read_b64 v[76:77], v13 offset:3840
    ds_read_b64 v[78:79], v13 offset:3968
    s_waitcnt lgkmcnt(0)
    v_pk_add_f32 v[16:17], v[16:17], v[48:49]
    v_pk_add_f32 v[18:19], v[18:19], v[50:51]
    v_pk_add_f32 v[20:21], v[20:21], v[52:53]
    v_pk_add_f32 v[22:23], v[22:23], v[54:55]
    v_pk_add_f32 v[24:25], v[24:25], v[56:57]
    v_pk_add_f32 v[26:27], v[26:27], v[58:59]
    v_pk_add_f32 v[28:29], v[28:29], v[60:61]
    v_pk_add_f32 v[30:31], v[30:31], v[62:63]
    v_pk_add_f32 v[32:33], v[32:33], v[64:65]
    v_pk_add_f32 v[34:35], v[34:35], v[66:67]
    v_pk_add_f32 v[36:37], v[36:37], v[68:69]
    v_pk_add_f32 v[38:39], v[38:39], v[70:71]
    v_pk_add_f32 v[40:41], v[40:41], v[72:73]
    v_pk_add_f32 v[42:43], v[42:43], v[74:75]
    v_pk_add_f32 v[44:45], v[44:45], v[76:77]
    v_pk_add_f32 v[46:47], v[46:47], v[78:79]
    v_pk_add_f32 v[16:17], v[16:17], v[32:33]
    v_pk_add_f32 v[18:19], v[18:19], v[34:35]
    v_pk_add_f32 v[20:21], v[20:21], v[36:37]
    v_pk_add_f32 v[22:23], v[22:23], v[38:39]
    v_pk_add_f32 v[24:25], v[24:25], v[40:41]
    v_pk_add_f32 v[26:27], v[26:27], v[42:43]
    v_pk_add_f32 v[28:29], v[28:29], v[44:45]
    v_pk_add_f32 v[30:31], v[30:31], v[46:47]
    v_pk_add_f32 v[16:17], v[16:17], v[24:25]
    v_pk_add_f32 v[18:19], v[18:19], v[26:27]
    v_pk_add_f32 v[20:21], v[20:21], v[28:29]
    v_pk_add_f32 v[22:23], v[22:23], v[30:31]
    v_pk_add_f32 v[16:17], v[16:17], v[20:21]
    v_pk_add_f32 v[18:19], v[18:19], v[22:23]
    v_pk_add_f32 v[16:17], v[16:17], v[18:19]
    v_mul_f32 v16, 0x3acccccd, v16
    v_mul_f32 v17, 0x3acccccd, v17
    v_fma_f32 v17, -v16, v16, v17
    v_max_f32 v17, 0, v17
    v_cvt_pk_bf16_f32 v16, v16, v16
    v_lshlrev_b32 v16, 16, v16
    v_cvt_pk_bf16_f32 v17, v17, v17
    v_lshlrev_b32 v17, 16, v17
    v_add_f32 v17, 0x3727c5ac, v17
    v_cvt_pk_bf16_f32 v17, v17, v17
    v_lshlrev_b32 v17, 16, v17
    v_sqrt_f32 v17, v17
    s_nop 0
    v_cvt_pk_bf16_f32 v17, v17, v17
    v_lshlrev_b32 v17, 16, v17
    v_rcp_f32 v17, v17
    s_nop 0
    s_lshl_b32 s3, s3, 3
    s_mov_b64 exec, 0xffff
    buffer_store_dwordx2 v[16:17], v13, s[16:19], s3 offen sc1
    s_mov_b64 exec, -1
    v_mov_b32 v8, 0
f_g1:
    buffer_load_dword v9, v8, s[28:31], 0 offen sc1
    s_waitcnt vmcnt(0)
    v_readfirstlane_b32 s60, v9
    s_cmp_lg_u32 s60, 0
    s_cbranch_scc1 f_g1_ok
    s_sleep 2
    s_branch f_g1
f_g1_ok:
f_st2:
    s_waitcnt vmcnt(0)
    s_barrier
    s_branch f_sig
f_mod:
    s_load_dwordx2 s[8:9], s[0:1], 96
    s_load_dwordx2 s[12:13], s[0:1], 88
    s_sub_u32 s6, s2, 128
    s_cmp_ge_u32 s6, 60
    s_cselect_b32 s3, 1, 0
    s_mul_i32 s7, s3, 60
    s_sub_u32 s6, s6, s7
    v_lshrrev_b32 v3, 3, v0
    s_mul_i32 s7, s3, 320
    v_add_u32 v4, s7, v3
    v_mul_u32_u24 v5, 7680, v4
    v_and_b32 v6, 7, v0
    v_lshl_add_u32 v5, v6, 4, v5
    s_lshl_b32 s7, s6, 7
    v_lshlrev_b32 v4, 1, v4
    s_waitcnt lgkmcnt(0)
    s_mov_b32 s10, 4915200
    s_mov_b32 s11, 0x00020000
    s_mov_b32 s14, 1280
    s_mov_b32 s15, 0x00020000
    s_mov_b32 s30, 256
    s_mov_b32 s31, 0x00020000
    s_add_u32 s16, s4, 0
    s_addc_u32 s17, s5, 0
    s_mov_b32 s18, 30720
    s_mov_b32 s19, 0x00020000
    s_add_u32 s64, s4, 114688
    s_addc_u32 s65, s5, 0
    s_mov_b32 s66, 4096
    s_mov_b32 s67, 0x00020000
    buffer_load_ushort v10, v4, s[12:15], 0 offen offset:0
    buffer_load_ushort v11, v4, s[12:15], 0 offen offset:64
    buffer_load_ushort v12, v4, s[12:15], 0 offen offset:128
    buffer_load_ushort v13, v4, s[12:15], 0 offen offset:192
    buffer_load_ushort v14, v4, s[12:15], 0 offen offset:256
    buffer_load_ushort v15, v4, s[12:15], 0 offen offset:320
    buffer_load_ushort v16, v4, s[12:15], 0 offen offset:384
    buffer_load_ushort v17, v4, s[12:15], 0 offen offset:448
    buffer_load_ushort v18, v4, s[12:15], 0 offen offset:512
    buffer_load_ushort v19, v4, s[12:15], 0 offen offset:576
    buffer_load_dwordx4 v[32:35], v5, s[8:11], s7 offen
    s_add_u32 s7, s7, 245760
    buffer_load_dwordx4 v[36:39], v5, s[8:11], s7 offen
    s_add_u32 s7, s7, 245760
    buffer_load_dwordx4 v[40:43], v5, s[8:11], s7 offen
    s_add_u32 s7, s7, 245760
    buffer_load_dwordx4 v[44:47], v5, s[8:11], s7 offen
    s_add_u32 s7, s7, 245760
    buffer_load_dwordx4 v[48:51], v5, s[8:11], s7 offen
    s_add_u32 s7, s7, 245760
    buffer_load_dwordx4 v[52:55], v5, s[8:11], s7 offen
    s_add_u32 s7, s7, 245760
    buffer_load_dwordx4 v[56:59], v5, s[8:11], s7 offen
    s_add_u32 s7, s7, 245760
    buffer_load_dwordx4 v[60:63], v5, s[8:11], s7 offen
    s_add_u32 s7, s7, 245760
    buffer_load_dwordx4 v[64:67], v5, s[8:11], s7 offen
    s_add_u32 s7, s7, 245760
    buffer_load_dwordx4 v[68:71], v5, s[8:11], s7 offen
    s_add_u32 s7, s7, 245760
    s_waitcnt vmcnt(10)
    v_lshlrev_b32 v10, 16, v10
    v_mul_f32 v7, 0xbfb8aa3b, v10
    v_exp_f32 v7, v7
    s_nop 0
    v_add_f32 v7, 1.0, v7
    v_rcp_f32 v7, v7
    s_nop 0
    v_mul_f32 v10, v10, v7
    v_cvt_pk_bf16_f32 v10, v10, v10
    v_lshlrev_b32 v10, 16, v10
    v_lshlrev_b32 v11, 16, v11
    v_mul_f32 v7, 0xbfb8aa3b, v11
    v_exp_f32 v7, v7
    s_nop 0
    v_add_f32 v7, 1.0, v7
    v_rcp_f32 v7, v7
    s_nop 0
    v_mul_f32 v11, v11, v7
    v_cvt_pk_bf16_f32 v11, v11, v11
    v_lshlrev_b32 v11, 16, v11
    v_lshlrev_b32 v12, 16, v12
    v_mul_f32 v7, 0xbfb8aa3b, v12
    v_exp_f32 v7, v7
    s_nop 0
    v_add_f32 v7, 1.0, v7
    v_rcp_f32 v7, v7
    s_nop 0
    v_mul_f32 v12, v12, v7
    v_cvt_pk_bf16_f32 v12, v12, v12
    v_lshlrev_b32 v12, 16, v12
    v_lshlrev_b32 v13, 16, v13
    v_mul_f32 v7, 0xbfb8aa3b, v13
    v_exp_f32 v7, v7
    s_nop 0
    v_add_f32 v7, 1.0, v7
    v_rcp_f32 v7, v7
    s_nop 0
    v_mul_f32 v13, v13, v7
    v_cvt_pk_bf16_f32 v13, v13, v13
    v_lshlrev_b32 v13, 16, v13
    v_lshlrev_b32 v14, 16, v14
    v_mul_f32 v7, 0xbfb8aa3b, v14
    v_exp_f32 v7, v7
    s_nop 0
    v_add_f32 v7, 1.0, v7
    v_rcp_f32 v7, v7
    s_nop 0
    v_mul_f32 v14, v14, v7
    v_cvt_pk_bf16_f32 v14, v14, v14
    v_lshlrev_b32 v14, 16, v14
    v_lshlrev_b32 v15, 16, v15
    v_mul_f32 v7, 0xbfb8aa3b, v15
    v_exp_f32 v7, v7
    s_nop 0
    v_add_f32 v7, 1.0, v7
    v_rcp_f32 v7, v7
    s_nop 0
    v_mul_f32 v15, v15, v7
    v_cvt_pk_bf16_f32 v15, v15, v15
    v_lshlrev_b32 v15, 16, v15
    v_lshlrev_b32 v16, 16, v16
    v_mul_f32 v7, 0xbfb8aa3b, v16
    v_exp_f32 v7, v7
    s_nop 0
    v_add_f32 v7, 1.0, v7
    v_rcp_f32 v7, v7
    s_nop 0
    v_mul_f32 v16, v16, v7
    v_cvt_pk_bf16_f32 v16, v16, v16
    v_lshlrev_b32 v16, 16, v16
    v_lshlrev_b32 v17, 16, v17
    v_mul_f32 v7, 0xbfb8aa3b, v17
    v_exp_f32 v7, v7
    s_nop 0
    v_add_f32 v7, 1.0, v7
    v_rcp_f32 v7, v7
    s_nop 0
    v_mul_f32 v17, v17, v7
    v_cvt_pk_bf16_f32 v17, v17, v17
    v_lshlrev_b32 v17, 16, v17
    v_lshlrev_b32 v18, 16, v18
    v_mul_f32 v7, 0xbfb8aa3b, v18
    v_exp_f32 v7, v7
    s_nop 0
    v_add_f32 v7, 1.0, v7
    v_rcp_f32 v7, v7
    s_nop 0
    v_mul_f32 v18, v18, v7
    v_cvt_pk_bf16_f32 v18, v18, v18
    v_lshlrev_b32 v18, 16, v18
    v_lshlrev_b32 v19, 16, v19
    v_mul_f32 v7, 0xbfb8aa3b, v19
    v_exp_f32 v7, v7
    s_nop 0
    v_add_f32 v7, 1.0, v7
    v_rcp_f32 v7, v7
    s_nop 0
    v_mul_f32 v19, v19, v7
    v_cvt_pk_bf16_f32 v19, v19, v19
    v_lshlrev_b32 v19, 16, v19
    s_waitcnt vmcnt(9)
    v_lshlrev_b32 v7, 16, v32
    v_and_b32 v8, 0xffff0000, v32
    v_mul_f32 v20, v10, v7
    v_mul_f32 v21, v10, v8
    v_lshlrev_b32 v7, 16, v33
    v_and_b32 v8, 0xffff0000, v33
    v_mul_f32 v22, v10, v7
    v_mul_f32 v23, v10, v8
    v_lshlrev_b32 v7, 16, v34
    v_and_b32 v8, 0xffff0000, v34
    v_mul_f32 v24, v10, v7
    v_mul_f32 v25, v10, v8
    v_lshlrev_b32 v7, 16, v35
    v_and_b32 v8, 0xffff0000, v35
    v_mul_f32 v26, v10, v7
    v_mul_f32 v27, v10, v8
    s_waitcnt vmcnt(8)
    v_lshlrev_b32 v7, 16, v36
    v_and_b32 v8, 0xffff0000, v36
    v_fmac_f32 v20, v11, v7
    v_fmac_f32 v21, v11, v8
    v_lshlrev_b32 v7, 16, v37
    v_and_b32 v8, 0xffff0000, v37
    v_fmac_f32 v22, v11, v7
    v_fmac_f32 v23, v11, v8
    v_lshlrev_b32 v7, 16, v38
    v_and_b32 v8, 0xffff0000, v38
    v_fmac_f32 v24, v11, v7
    v_fmac_f32 v25, v11, v8
    v_lshlrev_b32 v7, 16, v39
    v_and_b32 v8, 0xffff0000, v39
    v_fmac_f32 v26, v11, v7
    v_fmac_f32 v27, v11, v8
    s_waitcnt vmcnt(7)
    v_lshlrev_b32 v7, 16, v40
    v_and_b32 v8, 0xffff0000, v40
    v_fmac_f32 v20, v12, v7
    v_fmac_f32 v21, v12, v8
    v_lshlrev_b32 v7, 16, v41
    v_and_b32 v8, 0xffff0000, v41
    v_fmac_f32 v22, v12, v7
    v_fmac_f32 v23, v12, v8
    v_lshlrev_b32 v7, 16, v42
    v_and_b32 v8, 0xffff0000, v42
    v_fmac_f32 v24, v12, v7
    v_fmac_f32 v25, v12, v8
    v_lshlrev_b32 v7, 16, v43
    v_and_b32 v8, 0xffff0000, v43
    v_fmac_f32 v26, v12, v7
    v_fmac_f32 v27, v12, v8
    s_waitcnt vmcnt(6)
    v_lshlrev_b32 v7, 16, v44
    v_and_b32 v8, 0xffff0000, v44
    v_fmac_f32 v20, v13, v7
    v_fmac_f32 v21, v13, v8
    v_lshlrev_b32 v7, 16, v45
    v_and_b32 v8, 0xffff0000, v45
    v_fmac_f32 v22, v13, v7
    v_fmac_f32 v23, v13, v8
    v_lshlrev_b32 v7, 16, v46
    v_and_b32 v8, 0xffff0000, v46
    v_fmac_f32 v24, v13, v7
    v_fmac_f32 v25, v13, v8
    v_lshlrev_b32 v7, 16, v47
    v_and_b32 v8, 0xffff0000, v47
    v_fmac_f32 v26, v13, v7
    v_fmac_f32 v27, v13, v8
    s_waitcnt vmcnt(5)
    v_lshlrev_b32 v7, 16, v48
    v_and_b32 v8, 0xffff0000, v48
    v_fmac_f32 v20, v14, v7
    v_fmac_f32 v21, v14, v8
    v_lshlrev_b32 v7, 16, v49
    v_and_b32 v8, 0xffff0000, v49
    v_fmac_f32 v22, v14, v7
    v_fmac_f32 v23, v14, v8
    v_lshlrev_b32 v7, 16, v50
    v_and_b32 v8, 0xffff0000, v50
    v_fmac_f32 v24, v14, v7
    v_fmac_f32 v25, v14, v8
    v_lshlrev_b32 v7, 16, v51
    v_and_b32 v8, 0xffff0000, v51
    v_fmac_f32 v26, v14, v7
    v_fmac_f32 v27, v14, v8
    s_waitcnt vmcnt(4)
    v_lshlrev_b32 v7, 16, v52
    v_and_b32 v8, 0xffff0000, v52
    v_fmac_f32 v20, v15, v7
    v_fmac_f32 v21, v15, v8
    v_lshlrev_b32 v7, 16, v53
    v_and_b32 v8, 0xffff0000, v53
    v_fmac_f32 v22, v15, v7
    v_fmac_f32 v23, v15, v8
    v_lshlrev_b32 v7, 16, v54
    v_and_b32 v8, 0xffff0000, v54
    v_fmac_f32 v24, v15, v7
    v_fmac_f32 v25, v15, v8
    v_lshlrev_b32 v7, 16, v55
    v_and_b32 v8, 0xffff0000, v55
    v_fmac_f32 v26, v15, v7
    v_fmac_f32 v27, v15, v8
    s_waitcnt vmcnt(3)
    v_lshlrev_b32 v7, 16, v56
    v_and_b32 v8, 0xffff0000, v56
    v_fmac_f32 v20, v16, v7
    v_fmac_f32 v21, v16, v8
    v_lshlrev_b32 v7, 16, v57
    v_and_b32 v8, 0xffff0000, v57
    v_fmac_f32 v22, v16, v7
    v_fmac_f32 v23, v16, v8
    v_lshlrev_b32 v7, 16, v58
    v_and_b32 v8, 0xffff0000, v58
    v_fmac_f32 v24, v16, v7
    v_fmac_f32 v25, v16, v8
    v_lshlrev_b32 v7, 16, v59
    v_and_b32 v8, 0xffff0000, v59
    v_fmac_f32 v26, v16, v7
    v_fmac_f32 v27, v16, v8
    s_waitcnt vmcnt(2)
    v_lshlrev_b32 v7, 16, v60
    v_and_b32 v8, 0xffff0000, v60
    v_fmac_f32 v20, v17, v7
    v_fmac_f32 v21, v17, v8
    v_lshlrev_b32 v7, 16, v61
    v_and_b32 v8, 0xffff0000, v61
    v_fmac_f32 v22, v17, v7
    v_fmac_f32 v23, v17, v8
    v_lshlrev_b32 v7, 16, v62
    v_and_b32 v8, 0xffff0000, v62
    v_fmac_f32 v24, v17, v7
    v_fmac_f32 v25, v17, v8
    v_lshlrev_b32 v7, 16, v63
    v_and_b32 v8, 0xffff0000, v63
    v_fmac_f32 v26, v17, v7
    v_fmac_f32 v27, v17, v8
    s_waitcnt vmcnt(1)
    v_lshlrev_b32 v7, 16, v64
    v_and_b32 v8, 0xffff0000, v64
    v_fmac_f32 v20, v18, v7
    v_fmac_f32 v21, v18, v8
    v_lshlrev_b32 v7, 16, v65
    v_and_b32 v8, 0xffff0000, v65
    v_fmac_f32 v22, v18, v7
    v_fmac_f32 v23, v18, v8
    v_lshlrev_b32 v7, 16, v66
    v_and_b32 v8, 0xffff0000, v66
    v_fmac_f32 v24, v18, v7
    v_fmac_f32 v25, v18, v8
    v_lshlrev_b32 v7, 16, v67
    v_and_b32 v8, 0xffff0000, v67
    v_fmac_f32 v26, v18, v7
    v_fmac_f32 v27, v18, v8
    s_waitcnt vmcnt(0)
    v_lshlrev_b32 v7, 16, v68
    v_and_b32 v8, 0xffff0000, v68
    v_fmac_f32 v20, v19, v7
    v_fmac_f32 v21, v19, v8
    v_lshlrev_b32 v7, 16, v69
    v_and_b32 v8, 0xffff0000, v69
    v_fmac_f32 v22, v19, v7
    v_fmac_f32 v23, v19, v8
    v_lshlrev_b32 v7, 16, v70
    v_and_b32 v8, 0xffff0000, v70
    v_fmac_f32 v24, v19, v7
    v_fmac_f32 v25, v19, v8
    v_lshlrev_b32 v7, 16, v71
    v_and_b32 v8, 0xffff0000, v71
    v_fmac_f32 v26, v19, v7
    v_fmac_f32 v27, v19, v8
    v_lshlrev_b32 v7, 5, v0
    ds_write_b128 v7, v[20:23]
    ds_write_b128 v7, v[24:27] offset:16
    s_waitcnt lgkmcnt(0)
    s_barrier
    s_cmp_lg_u32 s32, 0
    s_cbranch_scc1 f_md2
    v_lshlrev_b32 v7, 2, v0
    ds_read_b32 v10, v7 offset:0
    ds_read_b32 v11, v7 offset:256
    ds_read_b32 v12, v7 offset:512
    ds_read_b32 v13, v7 offset:768
    ds_read_b32 v14, v7 offset:1024
    ds_read_b32 v15, v7 offset:1280
    ds_read_b32 v16, v7 offset:1536
    ds_read_b32 v17, v7 offset:1792
    ds_read_b32 v18, v7 offset:2048
    ds_read_b32 v19, v7 offset:2304
    ds_read_b32 v20, v7 offset:2560
    ds_read_b32 v21, v7 offset:2816
    ds_read_b32 v22, v7 offset:3072
    ds_read_b32 v23, v7 offset:3328
    ds_read_b32 v24, v7 offset:3584
    ds_read_b32 v25, v7 offset:3840
    ds_read_b32 v26, v7 offset:4096
    ds_read_b32 v27, v7 offset:4352
    ds_read_b32 v28, v7 offset:4608
    ds_read_b32 v29, v7 offset:4864
    ds_read_b32 v30, v7 offset:5120
    ds_read_b32 v31, v7 offset:5376
    ds_read_b32 v32, v7 offset:5632
    ds_read_b32 v33, v7 offset:5888
    ds_read_b32 v34, v7 offset:6144
    ds_read_b32 v35, v7 offset:6400
    ds_read_b32 v36, v7 offset:6656
    ds_read_b32 v37, v7 offset:6912
    ds_read_b32 v38, v7 offset:7168
    ds_read_b32 v39, v7 offset:7424
    ds_read_b32 v40, v7 offset:7680
    ds_read_b32 v41, v7 offset:7936
    s_waitcnt lgkmcnt(0)
    v_pk_add_f32 v[10:11], v[10:11], v[26:27]
    v_pk_add_f32 v[12:13], v[12:13], v[28:29]
    v_pk_add_f32 v[14:15], v[14:15], v[30:31]
    v_pk_add_f32 v[16:17], v[16:17], v[32:33]
    v_pk_add_f32 v[18:19], v[18:19], v[34:35]
    v_pk_add_f32 v[20:21], v[20:21], v[36:37]
    v_pk_add_f32 v[22:23], v[22:23], v[38:39]
    v_pk_add_f32 v[24:25], v[24:25], v[40:41]
    v_pk_add_f32 v[10:11], v[10:11], v[18:19]
    v_pk_add_f32 v[12:13], v[12:13], v[20:21]
    v_pk_add_f32 v[14:15], v[14:15], v[22:23]
    v_pk_add_f32 v[16:17], v[16:17], v[24:25]
    v_pk_add_f32 v[10:11], v[10:11], v[14:15]
    v_pk_add_f32 v[12:13], v[12:13], v[16:17]
    v_pk_add_f32 v[10:11], v[10:11], v[12:13]
    v_add_f32 v10, v10, v11
    s_mul_i32 s3, s3, 15360
    s_lshl_b32 s6, s6, 8
    s_add_u32 s3, s3, s6
    buffer_store_dword v10, v7, s[16:19], s3 offen sc1
    v_mov_b32 v8, 0
f_g2:
    buffer_load_dword v9, v8, s[28:31], 0 offen sc1
    s_waitcnt vmcnt(0)
    v_readfirstlane_b32 s60, v9
    s_cmp_lg_u32 s60, 0
    s_cbranch_scc1 f_g2_ok
    s_sleep 2
    s_branch f_g2
f_g2_ok:
f_md2:
f_sig:
    s_cmp_lg_u32 s32, 0
    s_cbranch_scc1 f_prep
    s_lshl_b32 s3, s2, 4
    v_mov_b32 v8, 0
    v_mov_b32 v9, 1
    s_mov_b64 exec, 1
    buffer_store_dword v9, v8, s[64:67], s3 offen sc1
    s_mov_b64 exec, -1
f_prep:
    s_setprio 0
    s_cmp_ge_u32 s2, 205
    s_cbranch_scc1 f_pend
    s_cmp_ge_u32 s2, 135
    s_cbranch_scc1 f_w2
    s_load_dwordx2 s[8:9], s[0:1], 64
    s_load_dwordx2 s[10:11], s[0:1], 72
    s_mul_i32 s3, s2, 2428
    s_lshr_b32 s3, s3, 16
    s_mul_i32 s6, s3, 27
    s_sub_u32 s6, s2, s6
    s_and_b32 s33, s32, 1
    s_lshr_b32 s34, s32, 1
    s_lshl_b32 s35, s34, 3
    v_lshrrev_b32 v3, 3, v1
    v_add_u32 v3, s35, v3
    v_and_b32 v4, 7, v1
    v_mul_u32_u24 v5, 27648, v3
    v_lshl_add_u32 v5, v4, 4, v5
    s_mul_i32 s7, s3, 442368
    s_lshl_b32 s36, s6, 7
    s_add_u32 s7, s7, s36
    s_waitcnt lgkmcnt(0)
    s_cmp_eq_u32 s33, 1
    s_cselect_b32 s8, s10, s8
    s_cselect_b32 s9, s11, s9
    s_mov_b32 s10, 2211840
    s_mov_b32 s11, 0x00020000
    s_add_u32 s12, s4, 0
    s_addc_u32 s13, s5, 0
    s_mov_b32 s14, 30720
    s_mov_b32 s15, 0x00020000
    s_add_u32 s16, s4, 10485760
    s_addc_u32 s17, s5, 0
    s_mov_b32 s18, 4423680
    s_mov_b32 s19, 0x00020000
    s_add_u32 s20, s4, 131072
    s_addc_u32 s21, s5, 0
    s_mov_b32 s22, 138240
    s_mov_b32 s23, 0x00020000
    buffer_load_dwordx4 v[16:19], v5, s[8:11], s7 offen
    s_add_u32 s7, s7, 3456
    buffer_load_dwordx4 v[20:23], v5, s[8:11], s7 offen
    s_add_u32 s7, s7, 3456
    buffer_load_dwordx4 v[24:27], v5, s[8:11], s7 offen
    s_add_u32 s7, s7, 3456
    buffer_load_dwordx4 v[28:31], v5, s[8:11], s7 offen
    s_add_u32 s7, s7, 3456
    buffer_load_dwordx4 v[32:35], v5, s[8:11], s7 offen
    s_add_u32 s7, s7, 3456
    buffer_load_dwordx4 v[36:39], v5, s[8:11], s7 offen
    s_add_u32 s7, s7, 3456
    buffer_load_dwordx4 v[40:43], v5, s[8:11], s7 offen
    s_add_u32 s7, s7, 3456
    buffer_load_dwordx4 v[44:47], v5, s[8:11], s7 offen
    s_add_u32 s7, s7, 3456
    s_cmp_lg_u32 s32, 0
    s_cbranch_scc1 f_pw_ok
    s_lshl_b32 s7, s3, 1
    s_add_u32 s7, s7, 158
    v_and_b32 v8, 1, v1
    v_mul_u32_u24 v8, 60, v8
    v_bfe_u32 v9, v1, 1, 1
    v_add3_u32 v8, v8, v9, s7
    v_bfe_u32 v9, v1, 2, 1
    v_mad_u32_u24 v10, v9, 10, v8
    v_lshlrev_b32 v8, 4, v10
f_pw:
    buffer_load_dword v9, v8, s[64:67], 0 offen offset:0 sc1
    s_waitcnt vmcnt(0)
    v_cmp_eq_u32 vcc, 1, v9
    s_nop 4
    s_cmp_eq_u64 vcc, -1
    s_cbranch_scc1 f_pw_ok
    s_sleep 4
    s_branch f_pw
f_pw_ok:
    s_barrier
    v_and_b32 v6, 127, v0
    v_lshlrev_b32 v6, 2, v6
    s_lshl_b32 s36, s3, 9
    s_mul_i32 s37, s34, 2560
    s_add_u32 s36, s36, 10240
    s_sub_u32 s36, s36, s37
    buffer_load_dword v8, v6, s[12:15], s36 offen sc1
    s_add_u32 s36, s36, 15360
    buffer_load_dword v9, v6, s[12:15], s36 offen sc1
    s_add_u32 s36, s36, 15360
    v_lshrrev_b32 v10, 1, v4
    v_and_b32 v11, 1, v4
    v_lshlrev_b32 v11, 4, v11
    s_lshl_b32 s36, s33, 3
    v_add_u32 v11, s36, v11
    v_lshl_add_u32 v13, v10, 5, v11
    v_lshlrev_b32 v12, 13, v10
    v_lshl_add_u32 v12, v3, 9, v12
    v_add_u32 v11, v11, v4
    v_lshl_add_u32 v12, v11, 4, v12
    s_cmp_eq_u32 s34, 0
    s_cselect_b32 s37, 1.0, 0
    s_waitcnt vmcnt(0)
    v_add_f32 v8, v8, v9
    v_cvt_pk_bf16_f32 v8, v8, v8
    v_lshlrev_b32 v8, 16, v8
    v_add_f32 v8, s37, v8
    v_cvt_pk_bf16_f32 v8, v8, v8
    v_lshlrev_b32 v8, 16, v8
    v_lshlrev_b32 v7, 2, v0
    ds_write_b32 v7, v8 offset:8192
    v_lshlrev_b32 v9, 5, v3
    s_waitcnt lgkmcnt(0)
    s_barrier
    ds_read_b128 v[48:51], v9 offset:8192
    ds_read_b128 v[52:55], v9 offset:8208
    ds_read_b128 v[56:59], v9 offset:8704
    ds_read_b128 v[60:63], v9 offset:8720
    v_mov_b32 v14, 0x3f803f80
    s_waitcnt lgkmcnt(0)
    v_mov_b32 v64, 0
    v_lshlrev_b32 v8, 16, v16
    v_mul_f32 v72, v56, v8
    v_lshlrev_b32 v9, 16, v20
    v_fmac_f32 v72, v57, v9
    v_pk_mul_f32 v[8:9], v[48:49], v[8:9]
    v_cvt_pk_bf16_f32 v80, v8, v9
    v_dot2c_f32_bf16 v64, v14, v80
    v_lshlrev_b32 v8, 16, v24
    v_fmac_f32 v72, v58, v8
    v_lshlrev_b32 v9, 16, v28
    v_fmac_f32 v72, v59, v9
    v_pk_mul_f32 v[8:9], v[50:51], v[8:9]
    v_cvt_pk_bf16_f32 v81, v8, v9
    v_dot2c_f32_bf16 v64, v14, v81
    v_lshlrev_b32 v8, 16, v32
    v_fmac_f32 v72, v60, v8
    v_lshlrev_b32 v9, 16, v36
    v_fmac_f32 v72, v61, v9
    v_pk_mul_f32 v[8:9], v[52:53], v[8:9]
    v_cvt_pk_bf16_f32 v82, v8, v9
    v_dot2c_f32_bf16 v64, v14, v82
    v_lshlrev_b32 v8, 16, v40
    v_fmac_f32 v72, v62, v8
    v_lshlrev_b32 v9, 16, v44
    v_fmac_f32 v72, v63, v9
    v_pk_mul_f32 v[8:9], v[54:55], v[8:9]
    v_cvt_pk_bf16_f32 v83, v8, v9
    v_dot2c_f32_bf16 v64, v14, v83
    v_xor_b32 v15, 0, v12
    ds_write_b128 v15, v[80:83] offset:25600
    v_mov_b32 v65, 0
    v_and_b32 v8, 0xffff0000, v16
    v_mul_f32 v73, v56, v8
    v_and_b32 v9, 0xffff0000, v20
    v_fmac_f32 v73, v57, v9
    v_pk_mul_f32 v[8:9], v[48:49], v[8:9]
    v_cvt_pk_bf16_f32 v84, v8, v9
    v_dot2c_f32_bf16 v65, v14, v84
    v_and_b32 v8, 0xffff0000, v24
    v_fmac_f32 v73, v58, v8
    v_and_b32 v9, 0xffff0000, v28
    v_fmac_f32 v73, v59, v9
    v_pk_mul_f32 v[8:9], v[50:51], v[8:9]
    v_cvt_pk_bf16_f32 v85, v8, v9
    v_dot2c_f32_bf16 v65, v14, v85
    v_and_b32 v8, 0xffff0000, v32
    v_fmac_f32 v73, v60, v8
    v_and_b32 v9, 0xffff0000, v36
    v_fmac_f32 v73, v61, v9
    v_pk_mul_f32 v[8:9], v[52:53], v[8:9]
    v_cvt_pk_bf16_f32 v86, v8, v9
    v_dot2c_f32_bf16 v65, v14, v86
    v_and_b32 v8, 0xffff0000, v40
    v_fmac_f32 v73, v62, v8
    v_and_b32 v9, 0xffff0000, v44
    v_fmac_f32 v73, v63, v9
    v_pk_mul_f32 v[8:9], v[54:55], v[8:9]
    v_cvt_pk_bf16_f32 v87, v8, v9
    v_dot2c_f32_bf16 v65, v14, v87
    v_xor_b32 v15, 16, v12
    ds_write_b128 v15, v[84:87] offset:25600
    v_mov_b32 v66, 0
    v_lshlrev_b32 v8, 16, v17
    v_mul_f32 v74, v56, v8
    v_lshlrev_b32 v9, 16, v21
    v_fmac_f32 v74, v57, v9
    v_pk_mul_f32 v[8:9], v[48:49], v[8:9]
    v_cvt_pk_bf16_f32 v88, v8, v9
    v_dot2c_f32_bf16 v66, v14, v88
    v_lshlrev_b32 v8, 16, v25
    v_fmac_f32 v74, v58, v8
    v_lshlrev_b32 v9, 16, v29
    v_fmac_f32 v74, v59, v9
    v_pk_mul_f32 v[8:9], v[50:51], v[8:9]
    v_cvt_pk_bf16_f32 v89, v8, v9
    v_dot2c_f32_bf16 v66, v14, v89
    v_lshlrev_b32 v8, 16, v33
    v_fmac_f32 v74, v60, v8
    v_lshlrev_b32 v9, 16, v37
    v_fmac_f32 v74, v61, v9
    v_pk_mul_f32 v[8:9], v[52:53], v[8:9]
    v_cvt_pk_bf16_f32 v90, v8, v9
    v_dot2c_f32_bf16 v66, v14, v90
    v_lshlrev_b32 v8, 16, v41
    v_fmac_f32 v74, v62, v8
    v_lshlrev_b32 v9, 16, v45
    v_fmac_f32 v74, v63, v9
    v_pk_mul_f32 v[8:9], v[54:55], v[8:9]
    v_cvt_pk_bf16_f32 v91, v8, v9
    v_dot2c_f32_bf16 v66, v14, v91
    v_xor_b32 v15, 32, v12
    ds_write_b128 v15, v[88:91] offset:25600
    v_mov_b32 v67, 0
    v_and_b32 v8, 0xffff0000, v17
    v_mul_f32 v75, v56, v8
    v_and_b32 v9, 0xffff0000, v21
    v_fmac_f32 v75, v57, v9
    v_pk_mul_f32 v[8:9], v[48:49], v[8:9]
    v_cvt_pk_bf16_f32 v92, v8, v9
    v_dot2c_f32_bf16 v67, v14, v92
    v_and_b32 v8, 0xffff0000, v25
    v_fmac_f32 v75, v58, v8
    v_and_b32 v9, 0xffff0000, v29
    v_fmac_f32 v75, v59, v9
    v_pk_mul_f32 v[8:9], v[50:51], v[8:9]
    v_cvt_pk_bf16_f32 v93, v8, v9
    v_dot2c_f32_bf16 v67, v14, v93
    v_and_b32 v8, 0xffff0000, v33
    v_fmac_f32 v75, v60, v8
    v_and_b32 v9, 0xffff0000, v37
    v_fmac_f32 v75, v61, v9
    v_pk_mul_f32 v[8:9], v[52:53], v[8:9]
    v_cvt_pk_bf16_f32 v94, v8, v9
    v_dot2c_f32_bf16 v67, v14, v94
    v_and_b32 v8, 0xffff0000, v41
    v_fmac_f32 v75, v62, v8
    v_and_b32 v9, 0xffff0000, v45
    v_fmac_f32 v75, v63, v9
    v_pk_mul_f32 v[8:9], v[54:55], v[8:9]
    v_cvt_pk_bf16_f32 v95, v8, v9
    v_dot2c_f32_bf16 v67, v14, v95
    v_xor_b32 v15, 48, v12
    ds_write_b128 v15, v[92:95] offset:25600
    v_mov_b32 v68, 0
    v_lshlrev_b32 v8, 16, v18
    v_mul_f32 v76, v56, v8
    v_lshlrev_b32 v9, 16, v22
    v_fmac_f32 v76, v57, v9
    v_pk_mul_f32 v[8:9], v[48:49], v[8:9]
    v_cvt_pk_bf16_f32 v96, v8, v9
    v_dot2c_f32_bf16 v68, v14, v96
    v_lshlrev_b32 v8, 16, v26
    v_fmac_f32 v76, v58, v8
    v_lshlrev_b32 v9, 16, v30
    v_fmac_f32 v76, v59, v9
    v_pk_mul_f32 v[8:9], v[50:51], v[8:9]
    v_cvt_pk_bf16_f32 v97, v8, v9
    v_dot2c_f32_bf16 v68, v14, v97
    v_lshlrev_b32 v8, 16, v34
    v_fmac_f32 v76, v60, v8
    v_lshlrev_b32 v9, 16, v38
    v_fmac_f32 v76, v61, v9
    v_pk_mul_f32 v[8:9], v[52:53], v[8:9]
    v_cvt_pk_bf16_f32 v98, v8, v9
    v_dot2c_f32_bf16 v68, v14, v98
    v_lshlrev_b32 v8, 16, v42
    v_fmac_f32 v76, v62, v8
    v_lshlrev_b32 v9, 16, v46
    v_fmac_f32 v76, v63, v9
    v_pk_mul_f32 v[8:9], v[54:55], v[8:9]
    v_cvt_pk_bf16_f32 v99, v8, v9
    v_dot2c_f32_bf16 v68, v14, v99
    v_xor_b32 v15, 64, v12
    ds_write_b128 v15, v[96:99] offset:25600
    v_mov_b32 v69, 0
    v_and_b32 v8, 0xffff0000, v18
    v_mul_f32 v77, v56, v8
    v_and_b32 v9, 0xffff0000, v22
    v_fmac_f32 v77, v57, v9
    v_pk_mul_f32 v[8:9], v[48:49], v[8:9]
    v_cvt_pk_bf16_f32 v100, v8, v9
    v_dot2c_f32_bf16 v69, v14, v100
    v_and_b32 v8, 0xffff0000, v26
    v_fmac_f32 v77, v58, v8
    v_and_b32 v9, 0xffff0000, v30
    v_fmac_f32 v77, v59, v9
    v_pk_mul_f32 v[8:9], v[50:51], v[8:9]
    v_cvt_pk_bf16_f32 v101, v8, v9
    v_dot2c_f32_bf16 v69, v14, v101
    v_and_b32 v8, 0xffff0000, v34
    v_fmac_f32 v77, v60, v8
    v_and_b32 v9, 0xffff0000, v38
    v_fmac_f32 v77, v61, v9
    v_pk_mul_f32 v[8:9], v[52:53], v[8:9]
    v_cvt_pk_bf16_f32 v102, v8, v9
    v_dot2c_f32_bf16 v69, v14, v102
    v_and_b32 v8, 0xffff0000, v42
    v_fmac_f32 v77, v62, v8
    v_and_b32 v9, 0xffff0000, v46
    v_fmac_f32 v77, v63, v9
    v_pk_mul_f32 v[8:9], v[54:55], v[8:9]
    v_cvt_pk_bf16_f32 v103, v8, v9
    v_dot2c_f32_bf16 v69, v14, v103
    v_xor_b32 v15, 80, v12
    ds_write_b128 v15, v[100:103] offset:25600
    v_mov_b32 v70, 0
    v_lshlrev_b32 v8, 16, v19
    v_mul_f32 v78, v56, v8
    v_lshlrev_b32 v9, 16, v23
    v_fmac_f32 v78, v57, v9
    v_pk_mul_f32 v[8:9], v[48:49], v[8:9]
    v_cvt_pk_bf16_f32 v104, v8, v9
    v_dot2c_f32_bf16 v70, v14, v104
    v_lshlrev_b32 v8, 16, v27
    v_fmac_f32 v78, v58, v8
    v_lshlrev_b32 v9, 16, v31
    v_fmac_f32 v78, v59, v9
    v_pk_mul_f32 v[8:9], v[50:51], v[8:9]
    v_cvt_pk_bf16_f32 v105, v8, v9
    v_dot2c_f32_bf16 v70, v14, v105
    v_lshlrev_b32 v8, 16, v35
    v_fmac_f32 v78, v60, v8
    v_lshlrev_b32 v9, 16, v39
    v_fmac_f32 v78, v61, v9
    v_pk_mul_f32 v[8:9], v[52:53], v[8:9]
    v_cvt_pk_bf16_f32 v106, v8, v9
    v_dot2c_f32_bf16 v70, v14, v106
    v_lshlrev_b32 v8, 16, v43
    v_fmac_f32 v78, v62, v8
    v_lshlrev_b32 v9, 16, v47
    v_fmac_f32 v78, v63, v9
    v_pk_mul_f32 v[8:9], v[54:55], v[8:9]
    v_cvt_pk_bf16_f32 v107, v8, v9
    v_dot2c_f32_bf16 v70, v14, v107
    v_xor_b32 v15, 96, v12
    ds_write_b128 v15, v[104:107] offset:25600
    v_mov_b32 v71, 0
    v_and_b32 v8, 0xffff0000, v19
    v_mul_f32 v79, v56, v8
    v_and_b32 v9, 0xffff0000, v23
    v_fmac_f32 v79, v57, v9
    v_pk_mul_f32 v[8:9], v[48:49], v[8:9]
    v_cvt_pk_bf16_f32 v108, v8, v9
    v_dot2c_f32_bf16 v71, v14, v108
    v_and_b32 v8, 0xffff0000, v27
    v_fmac_f32 v79, v58, v8
    v_and_b32 v9, 0xffff0000, v31
    v_fmac_f32 v79, v59, v9
    v_pk_mul_f32 v[8:9], v[50:51], v[8:9]
    v_cvt_pk_bf16_f32 v109, v8, v9
    v_dot2c_f32_bf16 v71, v14, v109
    v_and_b32 v8, 0xffff0000, v35
    v_fmac_f32 v79, v60, v8
    v_and_b32 v9, 0xffff0000, v39
    v_fmac_f32 v79, v61, v9
    v_pk_mul_f32 v[8:9], v[52:53], v[8:9]
    v_cvt_pk_bf16_f32 v110, v8, v9
    v_dot2c_f32_bf16 v71, v14, v110
    v_and_b32 v8, 0xffff0000, v43
    v_fmac_f32 v79, v62, v8
    v_and_b32 v9, 0xffff0000, v47
    v_fmac_f32 v79, v63, v9
    v_pk_mul_f32 v[8:9], v[54:55], v[8:9]
    v_cvt_pk_bf16_f32 v111, v8, v9
    v_dot2c_f32_bf16 v71, v14, v111
    v_xor_b32 v15, 112, v12
    ds_write_b128 v15, v[108:111] offset:25600
    v_lshlrev_b32 v9, 10, v3
    v_lshl_add_u32 v9, v13, 2, v9
    s_nop 1
    ds_write_b128 v9, v[64:67] offset:9216
    ds_write_b128 v9, v[68:71] offset:9232
    ds_write_b128 v9, v[72:75] offset:9728
    ds_write_b128 v9, v[76:79] offset:9744
    v_bfe_u32 v8, v1, 4, 1
    s_lshl_b32 s36, s32, 1
    v_add_u32 v8, s36, v8
    v_xor_b32 v8, v8, v1
    v_lshlrev_b32 v8, 4, v8
    s_lshl_b32 s36, s32, 13
    v_add_u32 v8, s36, v8
    v_lshlrev_b32 v9, 4, v1
    s_lshl_b32 s36, s6, 2
    s_add_u32 s36, s36, s32
    s_mul_i32 s36, s36, 40960
    s_lshl_b32 s37, s3, 13
    s_add_u32 s36, s36, s37
    s_add_u32 s37, s36, 4096
    s_waitcnt lgkmcnt(0)
    s_barrier
    ds_read_b128 v[32:35], v8 offset:25600
    ds_read_b128 v[36:39], v8 offset:26624
    ds_read_b128 v[40:43], v8 offset:27648
    ds_read_b128 v[44:47], v8 offset:28672
    ds_read_b128 v[48:51], v8 offset:29696
    ds_read_b128 v[52:55], v8 offset:30720
    ds_read_b128 v[56:59], v8 offset:31744
    ds_read_b128 v[60:63], v8 offset:32768
    s_waitcnt lgkmcnt(7)
    buffer_store_dwordx4 v[32:35], v9, s[16:19], s36 offen offset:0 sc1
    s_waitcnt lgkmcnt(6)
    buffer_store_dwordx4 v[36:39], v9, s[16:19], s36 offen offset:1024 sc1
    s_waitcnt lgkmcnt(5)
    buffer_store_dwordx4 v[40:43], v9, s[16:19], s36 offen offset:2048 sc1
    s_waitcnt lgkmcnt(4)
    buffer_store_dwordx4 v[44:47], v9, s[16:19], s36 offen offset:3072 sc1
    s_waitcnt lgkmcnt(3)
    buffer_store_dwordx4 v[48:51], v9, s[16:19], s37 offen offset:0 sc1
    s_waitcnt lgkmcnt(2)
    buffer_store_dwordx4 v[52:55], v9, s[16:19], s37 offen offset:1024 sc1
    s_waitcnt lgkmcnt(1)
    buffer_store_dwordx4 v[56:59], v9, s[16:19], s37 offen offset:2048 sc1
    s_waitcnt lgkmcnt(0)
    buffer_store_dwordx4 v[60:63], v9, s[16:19], s37 offen offset:3072 sc1
    ds_read_b32 v16, v7 offset:9216
    ds_read_b32 v17, v7 offset:10240
    ds_read_b32 v18, v7 offset:11264
    ds_read_b32 v19, v7 offset:12288
    ds_read_b32 v20, v7 offset:13312
    ds_read_b32 v21, v7 offset:14336
    ds_read_b32 v22, v7 offset:15360
    ds_read_b32 v23, v7 offset:16384
    ds_read_b32 v24, v7 offset:17408
    ds_read_b32 v25, v7 offset:18432
    ds_read_b32 v26, v7 offset:19456
    ds_read_b32 v27, v7 offset:20480
    ds_read_b32 v28, v7 offset:21504
    ds_read_b32 v29, v7 offset:22528
    ds_read_b32 v30, v7 offset:23552
    ds_read_b32 v31, v7 offset:24576
    s_lshl_b32 s3, s3, 1
    s_add_u32 s3, s3, s34
    s_mul_i32 s3, s3, 13824
    s_lshl_b32 s6, s6, 9
    s_add_u32 s3, s3, s6
    s_waitcnt lgkmcnt(0)
    v_add_f32 v16, v16, v24
    v_add_f32 v17, v17, v25
    v_add_f32 v18, v18, v26
    v_add_f32 v19, v19, v27
    v_add_f32 v20, v20, v28
    v_add_f32 v21, v21, v29
    v_add_f32 v22, v22, v30
    v_add_f32 v23, v23, v31
    v_add_f32 v16, v16, v20
    v_add_f32 v17, v17, v21
    v_add_f32 v18, v18, v22
    v_add_f32 v19, v19, v23
    v_add_f32 v16, v16, v18
    v_add_f32 v17, v17, v19
    v_add_f32 v16, v16, v17
    buffer_store_dword v16, v6, s[20:23], s3 offen
    s_endpgm
f_w2:
    s_load_dwordx2 s[8:9], s[0:1], 80
    s_sub_u32 s2, s2, 135
    s_mul_i32 s3, s2, 13108
    s_lshr_b32 s3, s3, 16
    s_mul_i32 s6, s3, 5
    s_sub_u32 s6, s2, s6
    s_lshl_b32 s3, s3, 4
    s_lshl_b32 s6, s6, 4
    v_lshrrev_b32 v3, 4, v0
    v_add_u32 v3, s3, v3
    v_and_b32 v4, 15, v0
    v_add_u32 v4, s6, v4
    v_lshrrev_b32 v5, 1, v3
    v_and_b32 v6, 1, v3
    v_lshlrev_b32 v6, 2, v6
    v_lshl_add_u32 v5, v5, 4, v6
    v_mul_u32_u24 v5, 1280, v5
    v_lshl_add_u32 v5, v4, 4, v5
    s_waitcnt lgkmcnt(0)
    s_mov_b32 s10, 2211840
    s_mov_b32 s11, 0x00020000
    s_add_u32 s16, s4, 15728640
    s_addc_u32 s17, s5, 0
    s_mov_b32 s18, 2211840
    s_mov_b32 s19, 0x00020000
    s_movk_i32 s7, 10240
    buffer_load_dwordx4 v[16:19], v5, s[8:11], 0 offen offset:0
    buffer_load_dwordx4 v[20:23], v5, s[8:11], 0 offen offset:1280
    buffer_load_dwordx4 v[24:27], v5, s[8:11], 0 offen offset:2560
    buffer_load_dwordx4 v[28:31], v5, s[8:11], 0 offen offset:3840
    buffer_load_dwordx4 v[32:35], v5, s[8:11], s7 offen offset:0
    buffer_load_dwordx4 v[36:39], v5, s[8:11], s7 offen offset:1280
    buffer_load_dwordx4 v[40:43], v5, s[8:11], s7 offen offset:2560
    buffer_load_dwordx4 v[44:47], v5, s[8:11], s7 offen offset:3840
    v_lshrrev_b32 v7, 2, v3
    v_mul_u32_u24 v7, 5120, v7
    v_and_b32 v8, 3, v3
    v_lshl_add_u32 v7, v8, 8, v7
    v_lshl_add_u32 v8, v4, 1, 0
    v_mul_u32_u24 v9, 3277, v8
    v_lshrrev_b32 v9, 16, v9
    v_mul_u32_u24 v10, 20, v9
    v_sub_u32 v8, v8, v10
    v_mul_u32_u24 v10, 13108, v8
    v_lshrrev_b32 v10, 16, v10
    v_mul_u32_u24 v11, 5, v10
    v_sub_u32 v8, v8, v11
    v_mul_u32_u24 v9, 276480, v9
    v_lshl_add_u32 v9, v8, 10, v9
    v_lshl_add_u32 v9, v10, 6, v9
    v_add_u32 v12, v9, v7
    v_lshl_add_u32 v8, v4, 1, 1
    v_mul_u32_u24 v9, 3277, v8
    v_lshrrev_b32 v9, 16, v9
    v_mul_u32_u24 v10, 20, v9
    v_sub_u32 v8, v8, v10
    v_mul_u32_u24 v10, 13108, v8
    v_lshrrev_b32 v10, 16, v10
    v_mul_u32_u24 v11, 5, v10
    v_sub_u32 v8, v8, v11
    v_mul_u32_u24 v9, 276480, v9
    v_lshl_add_u32 v9, v8, 10, v9
    v_lshl_add_u32 v9, v10, 6, v9
    v_add_u32 v13, v9, v7
    s_mov_b32 s36, 0x05040100
    s_mov_b32 s37, 0x07060302
    v_cmp_gt_u32 vcc, 216, v3
    s_and_saveexec_b64 s[6:7], vcc
    s_waitcnt vmcnt(0)
    v_perm_b32 v48, v20, v16, s36
    v_perm_b32 v49, v28, v24, s36
    v_perm_b32 v50, v36, v32, s36
    v_perm_b32 v51, v44, v40, s36
    buffer_store_dwordx4 v[48:51], v12, s[16:19], 0 offen offset:0
    v_perm_b32 v52, v20, v16, s37
    v_perm_b32 v53, v28, v24, s37
    v_perm_b32 v54, v36, v32, s37
    v_perm_b32 v55, v44, v40, s37
    buffer_store_dwordx4 v[52:55], v12, s[16:19], 0 offen offset:16
    v_perm_b32 v56, v21, v17, s36
    v_perm_b32 v57, v29, v25, s36
    v_perm_b32 v58, v37, v33, s36
    v_perm_b32 v59, v45, v41, s36
    buffer_store_dwordx4 v[56:59], v12, s[16:19], 0 offen offset:32
    v_perm_b32 v60, v21, v17, s37
    v_perm_b32 v61, v29, v25, s37
    v_perm_b32 v62, v37, v33, s37
    v_perm_b32 v63, v45, v41, s37
    buffer_store_dwordx4 v[60:63], v12, s[16:19], 0 offen offset:48
    v_perm_b32 v64, v22, v18, s36
    v_perm_b32 v65, v30, v26, s36
    v_perm_b32 v66, v38, v34, s36
    v_perm_b32 v67, v46, v42, s36
    buffer_store_dwordx4 v[64:67], v13, s[16:19], 0 offen offset:0
    v_perm_b32 v68, v22, v18, s37
    v_perm_b32 v69, v30, v26, s37
    v_perm_b32 v70, v38, v34, s37
    v_perm_b32 v71, v46, v42, s37
    buffer_store_dwordx4 v[68:71], v13, s[16:19], 0 offen offset:16
    v_perm_b32 v72, v23, v19, s36
    v_perm_b32 v73, v31, v27, s36
    v_perm_b32 v74, v39, v35, s36
    v_perm_b32 v75, v47, v43, s36
    buffer_store_dwordx4 v[72:75], v13, s[16:19], 0 offen offset:32
    v_perm_b32 v76, v23, v19, s37
    v_perm_b32 v77, v31, v27, s37
    v_perm_b32 v78, v39, v35, s37
    v_perm_b32 v79, v47, v43, s37
    buffer_store_dwordx4 v[76:79], v13, s[16:19], 0 offen offset:48
f_pend:
    s_endpgm
f_ipf:
    s_getpc_b64 s[8:9]
f_pcr:
    s_sub_u32 s8, s8, f_pcr-front_kernel
    s_subb_u32 s9, s9, 0
    v_lshlrev_b32 v3, 4, v0
    s_mov_b32 s10, code_end-front_kernel-16
    s_movk_i32 s11, 10
f_pcr_l:
    v_min_u32 v6, s10, v3
    v_mov_b32 v5, s9
    v_add_co_u32 v4, vcc, s8, v6
    v_addc_co_u32 v5, vcc, 0, v5, vcc
    global_load_dwordx4 v[60:63], v[4:5], off
    v_add_u32 v3, 4096, v3
    s_sub_u32 s11, s11, 1
    s_cmp_lg_u32 s11, 0
    s_cbranch_scc1 f_pcr_l
    s_waitcnt vmcnt(0)
    s_endpgm
.globl gemm1_kernel
.p2align 8
.type gemm1_kernel,@function
gemm1_kernel:
    s_cmp_ge_u32 s2, 256
    s_cbranch_scc1 k3_end
    s_load_dwordx2 s[4:5], s[0:1], 120
    s_load_dwordx2 s[28:29], s[0:1], 112
    s_mov_b32 s62, s2
    s_cmp_lt_u32 s2, 32
    s_cbranch_scc1 k3_st
    s_sub_u32 s2, s2, 32
    v_and_b32 v1, 63, v0
    v_lshrrev_b32 v2, 6, v0
    s_and_b32 s3, s2, 7
    v_readfirstlane_b32 s32, v2
    s_lshr_b32 s6, s2, 3
    s_lshr_b32 s7, s3, 1
    s_mul_i32 s7, s7, 28
    s_add_u32 s7, s7, s6
    s_and_b32 s3, s3, 1
    s_lshl_b32 s3, s3, 3
    s_and_b32 s6, s7, 7
    s_add_u32 s33, s3, s6
    s_lshr_b32 s34, s7, 3
    s_lshl_b32 s35, s34, 3
    s_add_u32 s35, s35, s32
    s_min_u32 s36, s35, 107
    s_mul_i32 s36, s36, 40960
    s_lshl_b32 s37, s32, 15
    s_lshl_b32 s3, s33, 10
    s_add_u32 s37, s37, s3
    s_lshl_b32 s38, s32, 11
    v_lshlrev_b32 v3, 4, v1
    s_waitcnt lgkmcnt(0)
    s_add_u32 s8, s4, 1048576
    s_addc_u32 s9, s5, 0
    s_mov_b32 s10, 2621440
    s_mov_b32 s11, 0x00020000
    s_add_u32 s12, s4, 10485760
    s_addc_u32 s13, s5, 0
    s_mov_b32 s14, 4423680
    s_mov_b32 s15, 0x00020000
    s_add_u32 s16, s4, 131072
    s_addc_u32 s17, s5, 0
    s_mov_b32 s18, 138240
    s_mov_b32 s19, 0x00020000
    s_add_u32 s20, s4, 18874368
    s_addc_u32 s21, s5, 0
    s_mov_b32 s22, 7077888
    s_mov_b32 s23, 0x00020000
    s_add_u32 s24, s4, 98304
    s_addc_u32 s25, s5, 0
    s_mov_b32 s26, 16384
    s_mov_b32 s27, 0x00020000
    s_mov_b32 s30, 256
    s_mov_b32 s31, 0x00020000
    v_and_b32 v4, 255, v0
    v_lshlrev_b32 v4, 2, v4
    s_lshr_b32 s3, s32, 2
    s_mul_i32 s3, s3, 13824
    s_lshl_b32 s6, s34, 10
    s_add_u32 s3, s3, s6
    buffer_load_dword v16, v4, s[16:19], s3 offen
    s_add_u32 s3, s3, 27648
    buffer_load_dword v17, v4, s[16:19], s3 offen
    s_add_u32 s3, s3, 27648
    buffer_load_dword v18, v4, s[16:19], s3 offen
    s_add_u32 s3, s3, 27648
    buffer_load_dword v19, v4, s[16:19], s3 offen
    s_add_u32 s3, s3, 27648
    buffer_load_dword v20, v4, s[16:19], s3 offen
    s_add_u32 s3, s3, 27648
    s_add_u32 m0, s38, 0
    s_add_u32 s3, s37, 0
    buffer_load_dwordx4 v3, s[8:11], s3 offen lds
    s_add_u32 m0, s38, 1024
    s_add_u32 s3, s37, 16384
    buffer_load_dwordx4 v3, s[8:11], s3 offen lds
    s_add_u32 s39, s36, 0
    buffer_load_dwordx4 a[0:3], v3, s[12:15], s39 offen offset:0
    buffer_load_dwordx4 a[4:7], v3, s[12:15], s39 offen offset:1024
    buffer_load_dwordx4 a[8:11], v3, s[12:15], s39 offen offset:2048
    buffer_load_dwordx4 a[12:15], v3, s[12:15], s39 offen offset:3072
    s_add_u32 m0, s38, 16384
    s_add_u32 s3, s37, 262144
    buffer_load_dwordx4 v3, s[8:11], s3 offen lds
    s_add_u32 m0, s38, 17408
    s_add_u32 s3, s37, 278528
    buffer_load_dwordx4 v3, s[8:11], s3 offen lds
    s_add_u32 s39, s36, 4096
    buffer_load_dwordx4 a[16:19], v3, s[12:15], s39 offen offset:0
    buffer_load_dwordx4 a[20:23], v3, s[12:15], s39 offen offset:1024
    buffer_load_dwordx4 a[24:27], v3, s[12:15], s39 offen offset:2048
    buffer_load_dwordx4 a[28:31], v3, s[12:15], s39 offen offset:3072
    s_add_u32 m0, s38, 32768
    s_add_u32 s3, s37, 524288
    buffer_load_dwordx4 v3, s[8:11], s3 offen lds
    s_add_u32 m0, s38, 33792
    s_add_u32 s3, s37, 540672
    buffer_load_dwordx4 v3, s[8:11], s3 offen lds
    s_add_u32 s39, s36, 8192
    buffer_load_dwordx4 a[32:35], v3, s[12:15], s39 offen offset:0
    buffer_load_dwordx4 a[36:39], v3, s[12:15], s39 offen offset:1024
    buffer_load_dwordx4 a[40:43], v3, s[12:15], s39 offen offset:2048
    buffer_load_dwordx4 a[44:47], v3, s[12:15], s39 offen offset:3072
    v_and_b32 v5, 31, v1
    v_lshrrev_b32 v6, 5, v1
    v_lshlrev_b32 v7, 11, v6
    v_lshl_add_u32 v7, v5, 3, v7
    s_and_b32 s6, s32, 3
    s_xor_b32 s40, s6, 0
    s_lshl_b32 s7, s40, 8
    v_add_u32 v8, s7, v7
    v_add_u32 v12, 49152, v8
    s_xor_b32 s41, s6, 1
    s_lshl_b32 s7, s41, 8
    v_add_u32 v9, s7, v7
    v_add_u32 v13, 49152, v9
    s_xor_b32 s42, s6, 2
    s_lshl_b32 s7, s42, 8
    v_add_u32 v10, s7, v7
    v_add_u32 v14, 49152, v10
    s_xor_b32 s43, s6, 3
    s_lshl_b32 s7, s43, 8
    v_add_u32 v11, s7, v7
    v_add_u32 v15, 49152, v11
    v_and_b32 v24, 1, v1
    v_lshlrev_b32 v24, 3, v24
    s_lshl_b32 s46, s33, 4
    v_add_u32 v26, s46, v24
    v_lshlrev_b32 v27, 3, v5
    s_lshl_b32 s47, s33, 10
    s_and_b32 s3, s62, 7
    s_lshr_b32 s6, s62, 3
    s_lshl_b32 s3, s3, 2
    s_and_b32 s54, s6, 3
    s_add_u32 s54, s54, s3
    s_lshr_b32 s55, s6, 2
    s_and_b32 s3, s32, 3
    s_mul_i32 s52, s55, 54
    s_add_u32 s52, s52, s3
    s_mul_i32 s52, s52, 5120
    s_mul_i32 s53, s3, 5120
    s_and_b32 s6, s54, 3
    s_lshl_b32 s6, s6, 2
    s_add_u32 s6, s6, s3
    s_lshl_b32 s6, s6, 10
    s_mul_i32 s58, s55, 276480
    s_add_u32 s58, s58, s6
    s_lshl_b32 s6, s55, 2
    s_add_u32 s6, s6, s3
    s_lshl_b32 s6, s6, 15
    s_lshl_b32 s59, s54, 10
    s_add_u32 s59, s59, s6
    s_add_u32 s48, s4, 15728640
    s_addc_u32 s49, s5, 0
    s_mov_b32 s50, 2211840
    s_mov_b32 s51, 0x00020000
    s_waitcnt vmcnt(16)
    v_add_f32 v16, v16, v17
    v_add_f32 v18, v18, v19
    v_add_f32 v16, v16, v20
    v_lshlrev_b32 v4, 2, v0
    v_add_f32 v16, v16, v18
    v_add_u32 v4, 81920, v4
    ds_write_b32 v4, v16
    s_barrier
    ds_read_b64 v[32:33], v8 offset:0
    ds_read_b64 v[34:35], v8 offset:1024
    ds_read_b64 v[36:37], v9 offset:0
    ds_read_b64 v[38:39], v9 offset:1024
    ds_read_b64 v[40:41], v10 offset:0
    ds_read_b64 v[42:43], v10 offset:1024
    ds_read_b64 v[44:45], v11 offset:0
    ds_read_b64 v[46:47], v11 offset:1024
    s_waitcnt vmcnt(15)
    s_waitcnt lgkmcnt(6)
    v_mfma_f32_32x32x16_bf16 v[64:79], a[0:3], v[32:35], 0
    ds_read_b64 v[48:49], v8 offset:4096
    ds_read_b64 v[50:51], v8 offset:5120
    s_waitcnt lgkmcnt(6)
    v_mfma_f32_32x32x16_bf16 v[80:95], a[0:3], v[36:39], 0
    ds_read_b64 v[52:53], v9 offset:4096
    ds_read_b64 v[54:55], v9 offset:5120
    s_add_u32 m0, s38, 49152
    s_add_u32 s3, s37, 786432
    buffer_load_dwordx4 v3, s[8:11], s3 offen lds
    s_waitcnt lgkmcnt(6)
    v_mfma_f32_32x32x16_bf16 v[96:111], a[0:3], v[40:43], 0
    ds_read_b64 v[56:57], v10 offset:4096
    ds_read_b64 v[58:59], v10 offset:5120
    s_add_u32 s39, s36, 12288
    buffer_load_dwordx4 a[48:51], v3, s[12:15], s39 offen offset:0
    s_waitcnt lgkmcnt(6)
    v_mfma_f32_32x32x16_bf16 v[112:127], a[0:3], v[44:47], 0
    ds_read_b64 v[60:61], v11 offset:4096
    ds_read_b64 v[62:63], v11 offset:5120
    s_waitcnt vmcnt(16)
    s_waitcnt lgkmcnt(6)
    v_mfma_f32_32x32x16_bf16 v[64:79], a[4:7], v[48:51], v[64:79]
    ds_read_b64 v[32:33], v8 offset:8192
    ds_read_b64 v[34:35], v8 offset:9216
    s_waitcnt lgkmcnt(6)
    v_mfma_f32_32x32x16_bf16 v[80:95], a[4:7], v[52:55], v[80:95]
    ds_read_b64 v[36:37], v9 offset:8192
    ds_read_b64 v[38:39], v9 offset:9216
    s_waitcnt lgkmcnt(6)
    v_mfma_f32_32x32x16_bf16 v[96:111], a[4:7], v[56:59], v[96:111]
    ds_read_b64 v[40:41], v10 offset:8192
    ds_read_b64 v[42:43], v10 offset:9216
    buffer_load_dwordx4 a[52:55], v3, s[12:15], s39 offen offset:1024
    s_waitcnt lgkmcnt(6)
    v_mfma_f32_32x32x16_bf16 v[112:127], a[4:7], v[60:63], v[112:127]
    ds_read_b64 v[44:45], v11 offset:8192
    ds_read_b64 v[46:47], v11 offset:9216
    s_waitcnt vmcnt(16)
    s_waitcnt lgkmcnt(6)
    v_mfma_f32_32x32x16_bf16 v[64:79], a[8:11], v[32:35], v[64:79]
    ds_read_b64 v[48:49], v8 offset:12288
    ds_read_b64 v[50:51], v8 offset:13312
    s_waitcnt lgkmcnt(6)
    v_mfma_f32_32x32x16_bf16 v[80:95], a[8:11], v[36:39], v[80:95]
    ds_read_b64 v[52:53], v9 offset:12288
    ds_read_b64 v[54:55], v9 offset:13312
    s_add_u32 m0, s38, 50176
    s_add_u32 s3, s37, 802816
    buffer_load_dwordx4 v3, s[8:11], s3 offen lds
    s_waitcnt lgkmcnt(6)
    v_mfma_f32_32x32x16_bf16 v[96:111], a[8:11], v[40:43], v[96:111]
    ds_read_b64 v[56:57], v10 offset:12288
    ds_read_b64 v[58:59], v10 offset:13312
    buffer_load_dwordx4 a[56:59], v3, s[12:15], s39 offen offset:2048
    s_waitcnt lgkmcnt(6)
    v_mfma_f32_32x32x16_bf16 v[112:127], a[8:11], v[44:47], v[112:127]
    ds_read_b64 v[60:61], v11 offset:12288
    ds_read_b64 v[62:63], v11 offset:13312
    s_waitcnt vmcnt(15)
    s_barrier
    s_waitcnt lgkmcnt(6)
    v_mfma_f32_32x32x16_bf16 v[64:79], a[12:15], v[48:51], v[64:79]
    ds_read_b64 v[32:33], v8 offset:16384
    ds_read_b64 v[34:35], v8 offset:17408
    s_waitcnt lgkmcnt(6)
    v_mfma_f32_32x32x16_bf16 v[80:95], a[12:15], v[52:55], v[80:95]
    ds_read_b64 v[36:37], v9 offset:16384
    ds_read_b64 v[38:39], v9 offset:17408
    s_waitcnt lgkmcnt(6)
    v_mfma_f32_32x32x16_bf16 v[96:111], a[12:15], v[56:59], v[96:111]
    ds_read_b64 v[40:41], v10 offset:16384
    ds_read_b64 v[42:43], v10 offset:17408
    buffer_load_dwordx4 a[60:63], v3, s[12:15], s39 offen offset:3072
    s_waitcnt lgkmcnt(6)
    v_mfma_f32_32x32x16_bf16 v[112:127], a[12:15], v[60:63], v[112:127]
    ds_read_b64 v[44:45], v11 offset:16384
    ds_read_b64 v[46:47], v11 offset:17408
    s_waitcnt vmcnt(15)
    s_waitcnt lgkmcnt(6)
    v_mfma_f32_32x32x16_bf16 v[64:79], a[16:19], v[32:35], v[64:79]
    ds_read_b64 v[48:49], v8 offset:20480
    ds_read_b64 v[50:51], v8 offset:21504
    s_waitcnt lgkmcnt(6)
    v_mfma_f32_32x32x16_bf16 v[80:95], a[16:19], v[36:39], v[80:95]
    ds_read_b64 v[52:53], v9 offset:20480
    ds_read_b64 v[54:55], v9 offset:21504
    s_add_u32 m0, s38, 65536
    s_add_u32 s3, s37, 1048576
    buffer_load_dwordx4 v3, s[8:11], s3 offen lds
    s_waitcnt lgkmcnt(6)
    v_mfma_f32_32x32x16_bf16 v[96:111], a[16:19], v[40:43], v[96:111]
    ds_read_b64 v[56:57], v10 offset:20480
    ds_read_b64 v[58:59], v10 offset:21504
    s_add_u32 s39, s36, 16384
    buffer_load_dwordx4 a[0:3], v3, s[12:15], s39 offen offset:0
    s_waitcnt lgkmcnt(6)
    v_mfma_f32_32x32x16_bf16 v[112:127], a[16:19], v[44:47], v[112:127]
    ds_read_b64 v[60:61], v11 offset:20480
    ds_read_b64 v[62:63], v11 offset:21504
    s_waitcnt vmcnt(16)
    s_waitcnt lgkmcnt(6)
    v_mfma_f32_32x32x16_bf16 v[64:79], a[20:23], v[48:51], v[64:79]
    ds_read_b64 v[32:33], v8 offset:24576
    ds_read_b64 v[34:35], v8 offset:25600
    s_waitcnt lgkmcnt(6)
    v_mfma_f32_32x32x16_bf16 v[80:95], a[20:23], v[52:55], v[80:95]
    ds_read_b64 v[36:37], v9 offset:24576
    ds_read_b64 v[38:39], v9 offset:25600
    s_waitcnt lgkmcnt(6)
    v_mfma_f32_32x32x16_bf16 v[96:111], a[20:23], v[56:59], v[96:111]
    ds_read_b64 v[40:41], v10 offset:24576
    ds_read_b64 v[42:43], v10 offset:25600
    buffer_load_dwordx4 a[4:7], v3, s[12:15], s39 offen offset:1024
    s_waitcnt lgkmcnt(6)
    v_mfma_f32_32x32x16_bf16 v[112:127], a[20:23], v[60:63], v[112:127]
    ds_read_b64 v[44:45], v11 offset:24576
    ds_read_b64 v[46:47], v11 offset:25600
    s_waitcnt vmcnt(16)
    s_waitcnt lgkmcnt(6)
    v_mfma_f32_32x32x16_bf16 v[64:79], a[24:27], v[32:35], v[64:79]
    ds_read_b64 v[48:49], v8 offset:28672
    ds_read_b64 v[50:51], v8 offset:29696
    s_waitcnt lgkmcnt(6)
    v_mfma_f32_32x32x16_bf16 v[80:95], a[24:27], v[36:39], v[80:95]
    ds_read_b64 v[52:53], v9 offset:28672
    ds_read_b64 v[54:55], v9 offset:29696
    s_add_u32 m0, s38, 66560
    s_add_u32 s3, s37, 1064960
    buffer_load_dwordx4 v3, s[8:11], s3 offen lds
    s_waitcnt lgkmcnt(6)
    v_mfma_f32_32x32x16_bf16 v[96:111], a[24:27], v[40:43], v[96:111]
    ds_read_b64 v[56:57], v10 offset:28672
    ds_read_b64 v[58:59], v10 offset:29696
    buffer_load_dwordx4 a[8:11], v3, s[12:15], s39 offen offset:2048
    s_waitcnt lgkmcnt(6)
    v_mfma_f32_32x32x16_bf16 v[112:127], a[24:27], v[44:47], v[112:127]
    ds_read_b64 v[60:61], v11 offset:28672
    ds_read_b64 v[62:63], v11 offset:29696
    s_waitcnt vmcnt(15)
    s_barrier
    s_waitcnt lgkmcnt(6)
    v_mfma_f32_32x32x16_bf16 v[64:79], a[28:31], v[48:51], v[64:79]
    ds_read_b64 v[32:33], v8 offset:32768
    ds_read_b64 v[34:35], v8 offset:33792
    s_waitcnt lgkmcnt(6)
    v_mfma_f32_32x32x16_bf16 v[80:95], a[28:31], v[52:55], v[80:95]
    ds_read_b64 v[36:37], v9 offset:32768
    ds_read_b64 v[38:39], v9 offset:33792
    s_waitcnt lgkmcnt(6)
    v_mfma_f32_32x32x16_bf16 v[96:111], a[28:31], v[56:59], v[96:111]
    ds_read_b64 v[40:41], v10 offset:32768
    ds_read_b64 v[42:43], v10 offset:33792
    buffer_load_dwordx4 a[12:15], v3, s[12:15], s39 offen offset:3072
    s_waitcnt lgkmcnt(6)
    v_mfma_f32_32x32x16_bf16 v[112:127], a[28:31], v[60:63], v[112:127]
    ds_read_b64 v[44:45], v11 offset:32768
    ds_read_b64 v[46:47], v11 offset:33792
    s_waitcnt vmcnt(15)
    s_waitcnt lgkmcnt(6)
    v_mfma_f32_32x32x16_bf16 v[64:79], a[32:35], v[32:35], v[64:79]
    ds_read_b64 v[48:49], v8 offset:36864
    ds_read_b64 v[50:51], v8 offset:37888
    s_waitcnt lgkmcnt(6)
    v_mfma_f32_32x32x16_bf16 v[80:95], a[32:35], v[36:39], v[80:95]
    ds_read_b64 v[52:53], v9 offset:36864
    ds_read_b64 v[54:55], v9 offset:37888
    s_add_u32 m0, s38, 0
    s_add_u32 s3, s37, 1310720
    buffer_load_dwordx4 v3, s[8:11], s3 offen lds
    s_waitcnt lgkmcnt(6)
    v_mfma_f32_32x32x16_bf16 v[96:111], a[32:35], v[40:43], v[96:111]
    ds_read_b64 v[56:57], v10 offset:36864
    ds_read_b64 v[58:59], v10 offset:37888
    s_add_u32 s39, s36, 20480
    buffer_load_dwordx4 a[16:19], v3, s[12:15], s39 offen offset:0
    s_waitcnt lgkmcnt(6)
    v_mfma_f32_32x32x16_bf16 v[112:127], a[32:35], v[44:47], v[112:127]
    ds_read_b64 v[60:61], v11 offset:36864
    ds_read_b64 v[62:63], v11 offset:37888
    s_waitcnt vmcnt(16)
    s_waitcnt lgkmcnt(6)
    v_mfma_f32_32x32x16_bf16 v[64:79], a[36:39], v[48:51], v[64:79]
    ds_read_b64 v[32:33], v8 offset:40960
    ds_read_b64 v[34:35], v8 offset:41984
    s_waitcnt lgkmcnt(6)
    v_mfma_f32_32x32x16_bf16 v[80:95], a[36:39], v[52:55], v[80:95]
    ds_read_b64 v[36:37], v9 offset:40960
    ds_read_b64 v[38:39], v9 offset:41984
    s_waitcnt lgkmcnt(6)
    v_mfma_f32_32x32x16_bf16 v[96:111], a[36:39], v[56:59], v[96:111]
    ds_read_b64 v[40:41], v10 offset:40960
    ds_read_b64 v[42:43], v10 offset:41984
    buffer_load_dwordx4 a[20:23], v3, s[12:15], s39 offen offset:1024
    s_waitcnt lgkmcnt(6)
    v_mfma_f32_32x32x16_bf16 v[112:127], a[36:39], v[60:63], v[112:127]
    ds_read_b64 v[44:45], v11 offset:40960
    ds_read_b64 v[46:47], v11 offset:41984
    s_waitcnt vmcnt(16)
    s_waitcnt lgkmcnt(6)
    v_mfma_f32_32x32x16_bf16 v[64:79], a[40:43], v[32:35], v[64:79]
    ds_read_b64 v[48:49], v8 offset:45056
    ds_read_b64 v[50:51], v8 offset:46080
    s_waitcnt lgkmcnt(6)
    v_mfma_f32_32x32x16_bf16 v[80:95], a[40:43], v[36:39], v[80:95]
    ds_read_b64 v[52:53], v9 offset:45056
    ds_read_b64 v[54:55], v9 offset:46080
    s_add_u32 m0, s38, 1024
    s_add_u32 s3, s37, 1327104
    buffer_load_dwordx4 v3, s[8:11], s3 offen lds
    s_waitcnt lgkmcnt(6)
    v_mfma_f32_32x32x16_bf16 v[96:111], a[40:43], v[40:43], v[96:111]
    ds_read_b64 v[56:57], v10 offset:45056
    ds_read_b64 v[58:59], v10 offset:46080
    buffer_load_dwordx4 a[24:27], v3, s[12:15], s39 offen offset:2048
    s_waitcnt lgkmcnt(6)
    v_mfma_f32_32x32x16_bf16 v[112:127], a[40:43], v[44:47], v[112:127]
    ds_read_b64 v[60:61], v11 offset:45056
    ds_read_b64 v[62:63], v11 offset:46080
    s_waitcnt vmcnt(13)
    s_barrier
    s_waitcnt lgkmcnt(6)
    v_mfma_f32_32x32x16_bf16 v[64:79], a[44:47], v[48:51], v[64:79]
    ds_read_b64 v[32:33], v12 offset:0
    ds_read_b64 v[34:35], v12 offset:1024
    s_waitcnt lgkmcnt(6)
    v_mfma_f32_32x32x16_bf16 v[80:95], a[44:47], v[52:55], v[80:95]
    ds_read_b64 v[36:37], v13 offset:0
    ds_read_b64 v[38:39], v13 offset:1024
    s_waitcnt lgkmcnt(6)
    v_mfma_f32_32x32x16_bf16 v[96:111], a[44:47], v[56:59], v[96:111]
    ds_read_b64 v[40:41], v14 offset:0
    ds_read_b64 v[42:43], v14 offset:1024
    buffer_load_dwordx4 a[28:31], v3, s[12:15], s39 offen offset:3072
    s_waitcnt lgkmcnt(6)
    v_mfma_f32_32x32x16_bf16 v[112:127], a[44:47], v[60:63], v[112:127]
    ds_read_b64 v[44:45], v15 offset:0
    ds_read_b64 v[46:47], v15 offset:1024
    s_waitcnt lgkmcnt(6)
    v_mfma_f32_32x32x16_bf16 v[64:79], a[48:51], v[32:35], v[64:79]
    ds_read_b64 v[48:49], v12 offset:4096
    ds_read_b64 v[50:51], v12 offset:5120
    s_waitcnt lgkmcnt(6)
    v_mfma_f32_32x32x16_bf16 v[80:95], a[48:51], v[36:39], v[80:95]
    ds_read_b64 v[52:53], v13 offset:4096
    ds_read_b64 v[54:55], v13 offset:5120
    s_add_u32 m0, s38, 16384
    s_add_u32 s3, s37, 1572864
    buffer_load_dwordx4 v3, s[8:11], s3 offen lds
    s_waitcnt lgkmcnt(6)
    v_mfma_f32_32x32x16_bf16 v[96:111], a[48:51], v[40:43], v[96:111]
    ds_read_b64 v[56:57], v14 offset:4096
    ds_read_b64 v[58:59], v14 offset:5120
    s_add_u32 s39, s36, 24576
    buffer_load_dwordx4 a[32:35], v3, s[12:15], s39 offen offset:0
    s_waitcnt lgkmcnt(6)
    v_mfma_f32_32x32x16_bf16 v[112:127], a[48:51], v[44:47], v[112:127]
    ds_read_b64 v[60:61], v15 offset:4096
    ds_read_b64 v[62:63], v15 offset:5120
    s_waitcnt lgkmcnt(6)
    v_mfma_f32_32x32x16_bf16 v[64:79], a[52:55], v[48:51], v[64:79]
    ds_read_b64 v[32:33], v12 offset:8192
    ds_read_b64 v[34:35], v12 offset:9216
    s_waitcnt lgkmcnt(6)
    v_mfma_f32_32x32x16_bf16 v[80:95], a[52:55], v[52:55], v[80:95]
    ds_read_b64 v[36:37], v13 offset:8192
    ds_read_b64 v[38:39], v13 offset:9216
    s_waitcnt lgkmcnt(6)
    v_mfma_f32_32x32x16_bf16 v[96:111], a[52:55], v[56:59], v[96:111]
    ds_read_b64 v[40:41], v14 offset:8192
    ds_read_b64 v[42:43], v14 offset:9216
    buffer_load_dwordx4 a[36:39], v3, s[12:15], s39 offen offset:1024
    s_waitcnt lgkmcnt(6)
    v_mfma_f32_32x32x16_bf16 v[112:127], a[52:55], v[60:63], v[112:127]
    ds_read_b64 v[44:45], v15 offset:8192
    ds_read_b64 v[46:47], v15 offset:9216
    s_waitcnt vmcnt(16)
    s_waitcnt lgkmcnt(6)
    v_mfma_f32_32x32x16_bf16 v[64:79], a[56:59], v[32:35], v[64:79]
    ds_read_b64 v[48:49], v12 offset:12288
    ds_read_b64 v[50:51], v12 offset:13312
    s_waitcnt lgkmcnt(6)
    v_mfma_f32_32x32x16_bf16 v[80:95], a[56:59], v[36:39], v[80:95]
    ds_read_b64 v[52:53], v13 offset:12288
    ds_read_b64 v[54:55], v13 offset:13312
    s_add_u32 m0, s38, 17408
    s_add_u32 s3, s37, 1589248
    buffer_load_dwordx4 v3, s[8:11], s3 offen lds
    s_waitcnt lgkmcnt(6)
    v_mfma_f32_32x32x16_bf16 v[96:111], a[56:59], v[40:43], v[96:111]
    ds_read_b64 v[56:57], v14 offset:12288
    ds_read_b64 v[58:59], v14 offset:13312
    buffer_load_dwordx4 a[40:43], v3, s[12:15], s39 offen offset:2048
    s_waitcnt lgkmcnt(6)
    v_mfma_f32_32x32x16_bf16 v[112:127], a[56:59], v[44:47], v[112:127]
    ds_read_b64 v[60:61], v15 offset:12288
    ds_read_b64 v[62:63], v15 offset:13312
    s_waitcnt vmcnt(13)
    s_barrier
    s_waitcnt lgkmcnt(6)
    v_mfma_f32_32x32x16_bf16 v[64:79], a[60:63], v[48:51], v[64:79]
    ds_read_b64 v[32:33], v12 offset:16384
    ds_read_b64 v[34:35], v12 offset:17408
    s_waitcnt lgkmcnt(6)
    v_mfma_f32_32x32x16_bf16 v[80:95], a[60:63], v[52:55], v[80:95]
    ds_read_b64 v[36:37], v13 offset:16384
    ds_read_b64 v[38:39], v13 offset:17408
    s_waitcnt lgkmcnt(6)
    v_mfma_f32_32x32x16_bf16 v[96:111], a[60:63], v[56:59], v[96:111]
    ds_read_b64 v[40:41], v14 offset:16384
    ds_read_b64 v[42:43], v14 offset:17408
    buffer_load_dwordx4 a[44:47], v3, s[12:15], s39 offen offset:3072
    s_waitcnt lgkmcnt(6)
    v_mfma_f32_32x32x16_bf16 v[112:127], a[60:63], v[60:63], v[112:127]
    ds_read_b64 v[44:45], v15 offset:16384
    ds_read_b64 v[46:47], v15 offset:17408
    s_waitcnt lgkmcnt(6)
    v_mfma_f32_32x32x16_bf16 v[64:79], a[0:3], v[32:35], v[64:79]
    ds_read_b64 v[48:49], v12 offset:20480
    ds_read_b64 v[50:51], v12 offset:21504
    s_waitcnt lgkmcnt(6)
    v_mfma_f32_32x32x16_bf16 v[80:95], a[0:3], v[36:39], v[80:95]
    ds_read_b64 v[52:53], v13 offset:20480
    ds_read_b64 v[54:55], v13 offset:21504
    s_add_u32 m0, s38, 32768
    s_add_u32 s3, s37, 1835008
    buffer_load_dwordx4 v3, s[8:11], s3 offen lds
    s_waitcnt lgkmcnt(6)
    v_mfma_f32_32x32x16_bf16 v[96:111], a[0:3], v[40:43], v[96:111]
    ds_read_b64 v[56:57], v14 offset:20480
    ds_read_b64 v[58:59], v14 offset:21504
    s_add_u32 s39, s36, 28672
    buffer_load_dwordx4 a[48:51], v3, s[12:15], s39 offen offset:0
    s_waitcnt lgkmcnt(6)
    v_mfma_f32_32x32x16_bf16 v[112:127], a[0:3], v[44:47], v[112:127]
    ds_read_b64 v[60:61], v15 offset:20480
    ds_read_b64 v[62:63], v15 offset:21504
    s_waitcnt lgkmcnt(6)
    v_mfma_f32_32x32x16_bf16 v[64:79], a[4:7], v[48:51], v[64:79]
    ds_read_b64 v[32:33], v12 offset:24576
    ds_read_b64 v[34:35], v12 offset:25600
    s_waitcnt lgkmcnt(6)
    v_mfma_f32_32x32x16_bf16 v[80:95], a[4:7], v[52:55], v[80:95]
    ds_read_b64 v[36:37], v13 offset:24576
    ds_read_b64 v[38:39], v13 offset:25600
    s_waitcnt lgkmcnt(6)
    v_mfma_f32_32x32x16_bf16 v[96:111], a[4:7], v[56:59], v[96:111]
    ds_read_b64 v[40:41], v14 offset:24576
    ds_read_b64 v[42:43], v14 offset:25600
    buffer_load_dwordx4 a[52:55], v3, s[12:15], s39 offen offset:1024
    s_waitcnt lgkmcnt(6)
    v_mfma_f32_32x32x16_bf16 v[112:127], a[4:7], v[60:63], v[112:127]
    ds_read_b64 v[44:45], v15 offset:24576
    ds_read_b64 v[46:47], v15 offset:25600
    s_waitcnt vmcnt(16)
    s_waitcnt lgkmcnt(6)
    v_mfma_f32_32x32x16_bf16 v[64:79], a[8:11], v[32:35], v[64:79]
    ds_read_b64 v[48:49], v12 offset:28672
    ds_read_b64 v[50:51], v12 offset:29696
    s_waitcnt lgkmcnt(6)
    v_mfma_f32_32x32x16_bf16 v[80:95], a[8:11], v[36:39], v[80:95]
    ds_read_b64 v[52:53], v13 offset:28672
    ds_read_b64 v[54:55], v13 offset:29696
    s_add_u32 m0, s38, 33792
    s_add_u32 s3, s37, 1851392
    buffer_load_dwordx4 v3, s[8:11], s3 offen lds
    s_waitcnt lgkmcnt(6)
    v_mfma_f32_32x32x16_bf16 v[96:111], a[8:11], v[40:43], v[96:111]
    ds_read_b64 v[56:57], v14 offset:28672
    ds_read_b64 v[58:59], v14 offset:29696
    buffer_load_dwordx4 a[56:59], v3, s[12:15], s39 offen offset:2048
    s_waitcnt lgkmcnt(6)
    v_mfma_f32_32x32x16_bf16 v[112:127], a[8:11], v[44:47], v[112:127]
    ds_read_b64 v[60:61], v15 offset:28672
    ds_read_b64 v[62:63], v15 offset:29696
    s_waitcnt vmcnt(13)
    s_barrier
    s_waitcnt lgkmcnt(6)
    v_mfma_f32_32x32x16_bf16 v[64:79], a[12:15], v[48:51], v[64:79]
    ds_read_b64 v[32:33], v8 offset:0
    ds_read_b64 v[34:35], v8 offset:1024
    s_waitcnt lgkmcnt(6)
    v_mfma_f32_32x32x16_bf16 v[80:95], a[12:15], v[52:55], v[80:95]
    ds_read_b64 v[36:37], v9 offset:0
    ds_read_b64 v[38:39], v9 offset:1024
    s_waitcnt lgkmcnt(6)
    v_mfma_f32_32x32x16_bf16 v[96:111], a[12:15], v[56:59], v[96:111]
    ds_read_b64 v[40:41], v10 offset:0
    ds_read_b64 v[42:43], v10 offset:1024
    buffer_load_dwordx4 a[60:63], v3, s[12:15], s39 offen offset:3072
    s_waitcnt lgkmcnt(6)
    v_mfma_f32_32x32x16_bf16 v[112:127], a[12:15], v[60:63], v[112:127]
    ds_read_b64 v[44:45], v11 offset:0
    ds_read_b64 v[46:47], v11 offset:1024
    s_waitcnt lgkmcnt(6)
    v_mfma_f32_32x32x16_bf16 v[64:79], a[16:19], v[32:35], v[64:79]
    ds_read_b64 v[48:49], v8 offset:4096
    ds_read_b64 v[50:51], v8 offset:5120
    s_waitcnt lgkmcnt(6)
    v_mfma_f32_32x32x16_bf16 v[80:95], a[16:19], v[36:39], v[80:95]
    ds_read_b64 v[52:53], v9 offset:4096
    ds_read_b64 v[54:55], v9 offset:5120
    s_add_u32 m0, s38, 49152
    s_add_u32 s3, s37, 2097152
    buffer_load_dwordx4 v3, s[8:11], s3 offen lds
    s_waitcnt lgkmcnt(6)
    v_mfma_f32_32x32x16_bf16 v[96:111], a[16:19], v[40:43], v[96:111]
    ds_read_b64 v[56:57], v10 offset:4096
    ds_read_b64 v[58:59], v10 offset:5120
    s_add_u32 s39, s36, 32768
    buffer_load_dwordx4 a[0:3], v3, s[12:15], s39 offen offset:0
    s_waitcnt lgkmcnt(6)
    v_mfma_f32_32x32x16_bf16 v[112:127], a[16:19], v[44:47], v[112:127]
    ds_read_b64 v[60:61], v11 offset:4096
    ds_read_b64 v[62:63], v11 offset:5120
    s_waitcnt lgkmcnt(6)
    v_mfma_f32_32x32x16_bf16 v[64:79], a[20:23], v[48:51], v[64:79]
    ds_read_b64 v[32:33], v8 offset:8192
    ds_read_b64 v[34:35], v8 offset:9216
    s_waitcnt lgkmcnt(6)
    v_mfma_f32_32x32x16_bf16 v[80:95], a[20:23], v[52:55], v[80:95]
    ds_read_b64 v[36:37], v9 offset:8192
    ds_read_b64 v[38:39], v9 offset:9216
    s_waitcnt lgkmcnt(6)
    v_mfma_f32_32x32x16_bf16 v[96:111], a[20:23], v[56:59], v[96:111]
    ds_read_b64 v[40:41], v10 offset:8192
    ds_read_b64 v[42:43], v10 offset:9216
    buffer_load_dwordx4 a[4:7], v3, s[12:15], s39 offen offset:1024
    s_waitcnt lgkmcnt(6)
    v_mfma_f32_32x32x16_bf16 v[112:127], a[20:23], v[60:63], v[112:127]
    ds_read_b64 v[44:45], v11 offset:8192
    ds_read_b64 v[46:47], v11 offset:9216
    s_waitcnt vmcnt(16)
    s_waitcnt lgkmcnt(6)
    v_mfma_f32_32x32x16_bf16 v[64:79], a[24:27], v[32:35], v[64:79]
    ds_read_b64 v[48:49], v8 offset:12288
    ds_read_b64 v[50:51], v8 offset:13312
    buffer_load_dword v25, v24, s[28:31], s46 offen sc1
    s_waitcnt lgkmcnt(6)
    v_mfma_f32_32x32x16_bf16 v[80:95], a[24:27], v[36:39], v[80:95]
    ds_read_b64 v[52:53], v9 offset:12288
    ds_read_b64 v[54:55], v9 offset:13312
    s_add_u32 m0, s38, 50176
    s_add_u32 s3, s37, 2113536
    buffer_load_dwordx4 v3, s[8:11], s3 offen lds
    s_waitcnt lgkmcnt(6)
    v_mfma_f32_32x32x16_bf16 v[96:111], a[24:27], v[40:43], v[96:111]
    ds_read_b64 v[56:57], v10 offset:12288
    ds_read_b64 v[58:59], v10 offset:13312
    buffer_load_dwordx4 a[8:11], v3, s[12:15], s39 offen offset:2048
    s_waitcnt lgkmcnt(6)
    v_mfma_f32_32x32x16_bf16 v[112:127], a[24:27], v[44:47], v[112:127]
    ds_read_b64 v[60:61], v11 offset:12288
    ds_read_b64 v[62:63], v11 offset:13312
    s_waitcnt vmcnt(14)
    s_barrier
    s_waitcnt lgkmcnt(6)
    v_mfma_f32_32x32x16_bf16 v[64:79], a[28:31], v[48:51], v[64:79]
    ds_read_b64 v[32:33], v8 offset:16384
    ds_read_b64 v[34:35], v8 offset:17408
    s_waitcnt lgkmcnt(6)
    v_mfma_f32_32x32x16_bf16 v[80:95], a[28:31], v[52:55], v[80:95]
    ds_read_b64 v[36:37], v9 offset:16384
    ds_read_b64 v[38:39], v9 offset:17408
    s_waitcnt lgkmcnt(6)
    v_mfma_f32_32x32x16_bf16 v[96:111], a[28:31], v[56:59], v[96:111]
    ds_read_b64 v[40:41], v10 offset:16384
    ds_read_b64 v[42:43], v10 offset:17408
    buffer_load_dwordx4 a[12:15], v3, s[12:15], s39 offen offset:3072
    s_waitcnt lgkmcnt(6)
    v_mfma_f32_32x32x16_bf16 v[112:127], a[28:31], v[60:63], v[112:127]
    ds_read_b64 v[44:45], v11 offset:16384
    ds_read_b64 v[46:47], v11 offset:17408
    s_waitcnt lgkmcnt(6)
    v_mfma_f32_32x32x16_bf16 v[64:79], a[32:35], v[32:35], v[64:79]
    ds_read_b64 v[48:49], v8 offset:20480
    ds_read_b64 v[50:51], v8 offset:21504
    s_waitcnt lgkmcnt(6)
    v_mfma_f32_32x32x16_bf16 v[80:95], a[32:35], v[36:39], v[80:95]
    ds_read_b64 v[52:53], v9 offset:20480
    ds_read_b64 v[54:55], v9 offset:21504
    s_add_u32 m0, s38, 65536
    s_add_u32 s3, s37, 2359296
    buffer_load_dwordx4 v3, s[8:11], s3 offen lds
    s_waitcnt lgkmcnt(6)
    v_mfma_f32_32x32x16_bf16 v[96:111], a[32:35], v[40:43], v[96:111]
    ds_read_b64 v[56:57], v10 offset:20480
    ds_read_b64 v[58:59], v10 offset:21504
    s_add_u32 s39, s36, 36864
    buffer_load_dwordx4 a[16:19], v3, s[12:15], s39 offen offset:0
    s_waitcnt lgkmcnt(6)
    v_mfma_f32_32x32x16_bf16 v[112:127], a[32:35], v[44:47], v[112:127]
    ds_read_b64 v[60:61], v11 offset:20480
    ds_read_b64 v[62:63], v11 offset:21504
    s_waitcnt lgkmcnt(6)
    v_mfma_f32_32x32x16_bf16 v[64:79], a[36:39], v[48:51], v[64:79]
    ds_read_b64 v[32:33], v8 offset:24576
    ds_read_b64 v[34:35], v8 offset:25600
    s_waitcnt lgkmcnt(6)
    v_mfma_f32_32x32x16_bf16 v[80:95], a[36:39], v[52:55], v[80:95]
    ds_read_b64 v[36:37], v9 offset:24576
    ds_read_b64 v[38:39], v9 offset:25600
    s_waitcnt lgkmcnt(6)
    v_mfma_f32_32x32x16_bf16 v[96:111], a[36:39], v[56:59], v[96:111]
    ds_read_b64 v[40:41], v10 offset:24576
    ds_read_b64 v[42:43], v10 offset:25600
    buffer_load_dwordx4 a[20:23], v3, s[12:15], s39 offen offset:1024
    s_waitcnt lgkmcnt(6)
    v_mfma_f32_32x32x16_bf16 v[112:127], a[36:39], v[60:63], v[112:127]
    ds_read_b64 v[44:45], v11 offset:24576
    ds_read_b64 v[46:47], v11 offset:25600
    s_waitcnt vmcnt(17)
    s_waitcnt lgkmcnt(6)
    v_mfma_f32_32x32x16_bf16 v[64:79], a[40:43], v[32:35], v[64:79]
    ds_read_b64 v[48:49], v8 offset:28672
    ds_read_b64 v[50:51], v8 offset:29696
    s_waitcnt vmcnt(6)
    v_cmp_eq_u32 vcc, 1, v25
    s_nop 4
    s_cmp_eq_u64 vcc, -1
    s_cbranch_scc1 k3_p0_ok
k3_p0:
    buffer_load_dword v25, v26, s[28:31], 0 offen offset:0 sc1
    s_waitcnt vmcnt(0)
    v_cmp_eq_u32 vcc, 1, v25
    s_nop 4
    s_cmp_eq_u64 vcc, -1
    s_cbranch_scc1 k3_p0_ok
    s_sleep 4
    s_branch k3_p0
k3_p0_ok:
    s_waitcnt lgkmcnt(6)
    v_mfma_f32_32x32x16_bf16 v[80:95], a[40:43], v[36:39], v[80:95]
    ds_read_b64 v[52:53], v9 offset:28672
    ds_read_b64 v[54:55], v9 offset:29696
    s_add_u32 m0, s38, 66560
    s_add_u32 s3, s37, 2375680
    buffer_load_dwordx4 v3, s[8:11], s3 offen lds
    s_waitcnt lgkmcnt(6)
    v_mfma_f32_32x32x16_bf16 v[96:111], a[40:43], v[40:43], v[96:111]
    ds_read_b64 v[56:57], v10 offset:28672
    ds_read_b64 v[58:59], v10 offset:29696
    buffer_load_dwordx4 a[24:27], v3, s[12:15], s39 offen offset:2048
    s_waitcnt lgkmcnt(6)
    v_mfma_f32_32x32x16_bf16 v[112:127], a[40:43], v[44:47], v[112:127]
    ds_read_b64 v[60:61], v11 offset:28672
    ds_read_b64 v[62:63], v11 offset:29696
    s_barrier
    s_waitcnt lgkmcnt(6)
    v_mfma_f32_32x32x16_bf16 v[64:79], a[44:47], v[48:51], v[64:79]
    ds_read_b64 v[32:33], v8 offset:32768
    ds_read_b64 v[34:35], v8 offset:33792
    s_lshl_b32 s7, s40, 8
    s_add_u32 s7, s7, s47
    buffer_load_dwordx2 v[16:17], v27, s[24:27], s7 offen sc1
    s_waitcnt lgkmcnt(6)
    v_mfma_f32_32x32x16_bf16 v[80:95], a[44:47], v[52:55], v[80:95]
    ds_read_b64 v[36:37], v9 offset:32768
    ds_read_b64 v[38:39], v9 offset:33792
    s_lshl_b32 s7, s41, 8
    s_add_u32 s7, s7, s47
    buffer_load_dwordx2 v[18:19], v27, s[24:27], s7 offen sc1
    s_waitcnt lgkmcnt(6)
    v_mfma_f32_32x32x16_bf16 v[96:111], a[44:47], v[56:59], v[96:111]
    ds_read_b64 v[40:41], v10 offset:32768
    ds_read_b64 v[42:43], v10 offset:33792
    s_lshl_b32 s7, s42, 8
    s_add_u32 s7, s7, s47
    buffer_load_dwordx2 v[20:21], v27, s[24:27], s7 offen sc1
    buffer_load_dwordx4 a[28:31], v3, s[12:15], s39 offen offset:3072
    s_waitcnt lgkmcnt(6)
    v_mfma_f32_32x32x16_bf16 v[112:127], a[44:47], v[60:63], v[112:127]
    ds_read_b64 v[44:45], v11 offset:32768
    ds_read_b64 v[46:47], v11 offset:33792
    s_lshl_b32 s7, s43, 8
    s_add_u32 s7, s7, s47
    buffer_load_dwordx2 v[22:23], v27, s[24:27], s7 offen sc1
    s_cmp_ge_u32 s32, 4
    s_cbranch_scc1 k3_t1
    s_waitcnt lgkmcnt(6)
    v_mfma_f32_32x32x16_bf16 v[64:79], a[48:51], v[32:35], v[64:79]
    ds_read_b64 v[48:49], v8 offset:36864
    ds_read_b64 v[50:51], v8 offset:37888
    s_add_u32 s56, s52, 0
    buffer_load_dwordx4 a[32:35], v3, s[48:51], s56 offen offset:0
    s_waitcnt lgkmcnt(6)
    v_mfma_f32_32x32x16_bf16 v[80:95], a[48:51], v[36:39], v[80:95]
    ds_read_b64 v[52:53], v9 offset:36864
    ds_read_b64 v[54:55], v9 offset:37888
    buffer_load_dwordx4 a[36:39], v3, s[48:51], s56 offen offset:1024
    s_waitcnt lgkmcnt(6)
    v_mfma_f32_32x32x16_bf16 v[96:111], a[48:51], v[40:43], v[96:111]
    ds_read_b64 v[56:57], v10 offset:36864
    ds_read_b64 v[58:59], v10 offset:37888
    buffer_load_dwordx4 a[40:43], v3, s[48:51], s56 offen offset:2048
    s_waitcnt lgkmcnt(6)
    v_mfma_f32_32x32x16_bf16 v[112:127], a[48:51], v[44:47], v[112:127]
    ds_read_b64 v[60:61], v11 offset:36864
    ds_read_b64 v[62:63], v11 offset:37888
    buffer_load_dwordx4 a[44:47], v3, s[48:51], s56 offen offset:3072
    s_waitcnt lgkmcnt(6)
    v_mfma_f32_32x32x16_bf16 v[64:79], a[52:55], v[48:51], v[64:79]
    ds_read_b64 v[32:33], v8 offset:40960
    ds_read_b64 v[34:35], v8 offset:41984
    s_add_u32 s56, s52, 4096
    buffer_load_dwordx4 a[64:67], v3, s[48:51], s56 offen offset:0
    s_waitcnt lgkmcnt(6)
    v_mfma_f32_32x32x16_bf16 v[80:95], a[52:55], v[52:55], v[80:95]
    ds_read_b64 v[36:37], v9 offset:40960
    ds_read_b64 v[38:39], v9 offset:41984
    s_add_u32 s56, s52, 20480
    buffer_load_dwordx4 a[68:71], v3, s[48:51], s56 offen offset:0
    s_waitcnt lgkmcnt(6)
    v_mfma_f32_32x32x16_bf16 v[96:111], a[52:55], v[56:59], v[96:111]
    ds_read_b64 v[40:41], v10 offset:40960
    ds_read_b64 v[42:43], v10 offset:41984
    buffer_load_dwordx4 a[72:75], v3, s[48:51], s56 offen offset:1024
    s_waitcnt lgkmcnt(6)
    v_mfma_f32_32x32x16_bf16 v[112:127], a[52:55], v[60:63], v[112:127]
    ds_read_b64 v[44:45], v11 offset:40960
    ds_read_b64 v[46:47], v11 offset:41984
    buffer_load_dwordx4 a[76:79], v3, s[48:51], s56 offen offset:2048
    s_waitcnt lgkmcnt(6)
    v_mfma_f32_32x32x16_bf16 v[64:79], a[56:59], v[32:35], v[64:79]
    ds_read_b64 v[48:49], v8 offset:45056
    ds_read_b64 v[50:51], v8 offset:46080
    buffer_load_dwordx4 a[80:83], v3, s[48:51], s56 offen offset:3072
    s_waitcnt lgkmcnt(6)
    v_mfma_f32_32x32x16_bf16 v[80:95], a[56:59], v[36:39], v[80:95]
    ds_read_b64 v[52:53], v9 offset:45056
    ds_read_b64 v[54:55], v9 offset:46080
    s_add_u32 s56, s52, 24576
    buffer_load_dwordx4 a[84:87], v3, s[48:51], s56 offen offset:0
    s_waitcnt lgkmcnt(6)
    v_mfma_f32_32x32x16_bf16 v[96:111], a[56:59], v[40:43], v[96:111]
    ds_read_b64 v[56:57], v10 offset:45056
    ds_read_b64 v[58:59], v10 offset:46080
    s_add_u32 s56, s52, 40960
    buffer_load_dwordx4 a[88:91], v3, s[48:51], s56 offen offset:0
    s_waitcnt lgkmcnt(6)
    v_mfma_f32_32x32x16_bf16 v[112:127], a[56:59], v[44:47], v[112:127]
    ds_read_b64 v[60:61], v11 offset:45056
    ds_read_b64 v[62:63], v11 offset:46080
    buffer_load_dwordx4 a[92:95], v3, s[48:51], s56 offen offset:1024
    s_waitcnt vmcnt(24)
    s_barrier
    s_waitcnt lgkmcnt(6)
    v_mfma_f32_32x32x16_bf16 v[64:79], a[60:63], v[48:51], v[64:79]
    ds_read_b64 v[32:33], v12 offset:0
    ds_read_b64 v[34:35], v12 offset:1024
    buffer_load_dwordx4 a[96:99], v3, s[48:51], s56 offen offset:2048
    s_waitcnt lgkmcnt(6)
    v_mfma_f32_32x32x16_bf16 v[80:95], a[60:63], v[52:55], v[80:95]
    ds_read_b64 v[36:37], v13 offset:0
    ds_read_b64 v[38:39], v13 offset:1024
    buffer_load_dwordx4 a[100:103], v3, s[48:51], s56 offen offset:3072
    s_waitcnt lgkmcnt(6)
    v_mfma_f32_32x32x16_bf16 v[96:111], a[60:63], v[56:59], v[96:111]
    ds_read_b64 v[40:41], v14 offset:0
    ds_read_b64 v[42:43], v14 offset:1024
    s_add_u32 s56, s52, 45056
    buffer_load_dwordx4 a[104:107], v3, s[48:51], s56 offen offset:0
    s_waitcnt lgkmcnt(6)
    v_mfma_f32_32x32x16_bf16 v[112:127], a[60:63], v[60:63], v[112:127]
    ds_read_b64 v[44:45], v15 offset:0
    ds_read_b64 v[46:47], v15 offset:1024
    s_add_u32 s56, s52, 61440
    buffer_load_dwordx4 a[108:111], v3, s[48:51], s56 offen offset:0
    s_waitcnt lgkmcnt(6)
    v_mfma_f32_32x32x16_bf16 v[64:79], a[0:3], v[32:35], v[64:79]
    ds_read_b64 v[48:49], v12 offset:4096
    ds_read_b64 v[50:51], v12 offset:5120
    buffer_load_dwordx4 a[112:115], v3, s[48:51], s56 offen offset:1024
    s_waitcnt lgkmcnt(6)
    v_mfma_f32_32x32x16_bf16 v[80:95], a[0:3], v[36:39], v[80:95]
    ds_read_b64 v[52:53], v13 offset:4096
    ds_read_b64 v[54:55], v13 offset:5120
    buffer_load_dwordx4 a[116:119], v3, s[48:51], s56 offen offset:2048
    s_waitcnt lgkmcnt(6)
    v_mfma_f32_32x32x16_bf16 v[96:111], a[0:3], v[40:43], v[96:111]
    ds_read_b64 v[56:57], v14 offset:4096
    ds_read_b64 v[58:59], v14 offset:5120
    buffer_load_dwordx4 a[120:123], v3, s[48:51], s56 offen offset:3072
    s_waitcnt lgkmcnt(6)
    v_mfma_f32_32x32x16_bf16 v[112:127], a[0:3], v[44:47], v[112:127]
    ds_read_b64 v[60:61], v15 offset:4096
    ds_read_b64 v[62:63], v15 offset:5120
    s_add_u32 s56, s52, 65536
    buffer_load_dwordx4 a[124:127], v3, s[48:51], s56 offen offset:0
    s_waitcnt lgkmcnt(6)
    v_mfma_f32_32x32x16_bf16 v[64:79], a[4:7], v[48:51], v[64:79]
    ds_read_b64 v[32:33], v12 offset:8192
    ds_read_b64 v[34:35], v12 offset:9216
    s_waitcnt lgkmcnt(6)
    v_mfma_f32_32x32x16_bf16 v[80:95], a[4:7], v[52:55], v[80:95]
    ds_read_b64 v[36:37], v13 offset:8192
    ds_read_b64 v[38:39], v13 offset:9216
    s_waitcnt lgkmcnt(6)
    v_mfma_f32_32x32x16_bf16 v[96:111], a[4:7], v[56:59], v[96:111]
    ds_read_b64 v[40:41], v14 offset:8192
    ds_read_b64 v[42:43], v14 offset:9216
    s_waitcnt lgkmcnt(6)
    v_mfma_f32_32x32x16_bf16 v[112:127], a[4:7], v[60:63], v[112:127]
    ds_read_b64 v[44:45], v15 offset:8192
    ds_read_b64 v[46:47], v15 offset:9216
    s_waitcnt vmcnt(31)
    s_waitcnt lgkmcnt(6)
    v_mfma_f32_32x32x16_bf16 v[64:79], a[8:11], v[32:35], v[64:79]
    ds_read_b64 v[48:49], v12 offset:12288
    ds_read_b64 v[50:51], v12 offset:13312
    s_waitcnt lgkmcnt(6)
    v_mfma_f32_32x32x16_bf16 v[80:95], a[8:11], v[36:39], v[80:95]
    ds_read_b64 v[52:53], v13 offset:12288
    ds_read_b64 v[54:55], v13 offset:13312
    s_waitcnt lgkmcnt(6)
    v_mfma_f32_32x32x16_bf16 v[96:111], a[8:11], v[40:43], v[96:111]
    ds_read_b64 v[56:57], v14 offset:12288
    ds_read_b64 v[58:59], v14 offset:13312
    s_waitcnt lgkmcnt(6)
    v_mfma_f32_32x32x16_bf16 v[112:127], a[8:11], v[44:47], v[112:127]
    ds_read_b64 v[60:61], v15 offset:12288
    ds_read_b64 v[62:63], v15 offset:13312
    s_waitcnt vmcnt(26)
    s_barrier
    s_waitcnt lgkmcnt(6)
    v_mfma_f32_32x32x16_bf16 v[64:79], a[12:15], v[48:51], v[64:79]
    ds_read_b64 v[32:33], v12 offset:16384
    ds_read_b64 v[34:35], v12 offset:17408
    s_waitcnt lgkmcnt(6)
    v_mfma_f32_32x32x16_bf16 v[80:95], a[12:15], v[52:55], v[80:95]
    ds_read_b64 v[36:37], v13 offset:16384
    ds_read_b64 v[38:39], v13 offset:17408
    s_waitcnt lgkmcnt(6)
    v_mfma_f32_32x32x16_bf16 v[96:111], a[12:15], v[56:59], v[96:111]
    ds_read_b64 v[40:41], v14 offset:16384
    ds_read_b64 v[42:43], v14 offset:17408
    s_waitcnt lgkmcnt(6)
    v_mfma_f32_32x32x16_bf16 v[112:127], a[12:15], v[60:63], v[112:127]
    ds_read_b64 v[44:45], v15 offset:16384
    ds_read_b64 v[46:47], v15 offset:17408
    s_waitcnt lgkmcnt(6)
    v_mfma_f32_32x32x16_bf16 v[64:79], a[16:19], v[32:35], v[64:79]
    ds_read_b64 v[48:49], v12 offset:20480
    ds_read_b64 v[50:51], v12 offset:21504
    s_waitcnt lgkmcnt(6)
    v_mfma_f32_32x32x16_bf16 v[80:95], a[16:19], v[36:39], v[80:95]
    ds_read_b64 v[52:53], v13 offset:20480
    ds_read_b64 v[54:55], v13 offset:21504
    s_waitcnt lgkmcnt(6)
    v_mfma_f32_32x32x16_bf16 v[96:111], a[16:19], v[40:43], v[96:111]
    ds_read_b64 v[56:57], v14 offset:20480
    ds_read_b64 v[58:59], v14 offset:21504
    s_waitcnt lgkmcnt(6)
    v_mfma_f32_32x32x16_bf16 v[112:127], a[16:19], v[44:47], v[112:127]
    ds_read_b64 v[60:61], v15 offset:20480
    ds_read_b64 v[62:63], v15 offset:21504
    s_waitcnt lgkmcnt(6)
    v_mfma_f32_32x32x16_bf16 v[64:79], a[20:23], v[48:51], v[64:79]
    ds_read_b64 v[32:33], v12 offset:24576
    ds_read_b64 v[34:35], v12 offset:25600
    s_waitcnt lgkmcnt(6)
    v_mfma_f32_32x32x16_bf16 v[80:95], a[20:23], v[52:55], v[80:95]
    ds_read_b64 v[36:37], v13 offset:24576
    ds_read_b64 v[38:39], v13 offset:25600
    s_waitcnt lgkmcnt(6)
    v_mfma_f32_32x32x16_bf16 v[96:111], a[20:23], v[56:59], v[96:111]
    ds_read_b64 v[40:41], v14 offset:24576
    ds_read_b64 v[42:43], v14 offset:25600
    s_waitcnt lgkmcnt(6)
    v_mfma_f32_32x32x16_bf16 v[112:127], a[20:23], v[60:63], v[112:127]
    ds_read_b64 v[44:45], v15 offset:24576
    ds_read_b64 v[46:47], v15 offset:25600
    s_waitcnt vmcnt(25)
    s_waitcnt lgkmcnt(6)
    v_mfma_f32_32x32x16_bf16 v[64:79], a[24:27], v[32:35], v[64:79]
    ds_read_b64 v[48:49], v12 offset:28672
    ds_read_b64 v[50:51], v12 offset:29696
    s_waitcnt lgkmcnt(6)
    v_mfma_f32_32x32x16_bf16 v[80:95], a[24:27], v[36:39], v[80:95]
    ds_read_b64 v[52:53], v13 offset:28672
    ds_read_b64 v[54:55], v13 offset:29696
    s_waitcnt lgkmcnt(6)
    v_mfma_f32_32x32x16_bf16 v[96:111], a[24:27], v[40:43], v[96:111]
    ds_read_b64 v[56:57], v14 offset:28672
    ds_read_b64 v[58:59], v14 offset:29696
    s_waitcnt lgkmcnt(6)
    v_mfma_f32_32x32x16_bf16 v[112:127], a[24:27], v[44:47], v[112:127]
    ds_read_b64 v[60:61], v15 offset:28672
    ds_read_b64 v[62:63], v15 offset:29696
    s_waitcnt vmcnt(21)
    s_waitcnt lgkmcnt(6)
    v_mfma_f32_32x32x16_bf16 v[64:79], a[28:31], v[48:51], v[64:79]
    s_waitcnt lgkmcnt(4)
    v_mfma_f32_32x32x16_bf16 v[80:95], a[28:31], v[52:55], v[80:95]
    s_waitcnt lgkmcnt(2)
    v_mfma_f32_32x32x16_bf16 v[96:111], a[28:31], v[56:59], v[96:111]
    s_waitcnt lgkmcnt(0)
    v_mfma_f32_32x32x16_bf16 v[112:127], a[28:31], v[60:63], v[112:127]
    s_waitcnt vmcnt(20)
    s_branch k3_t2
k3_t1:
    s_waitcnt lgkmcnt(6)
    v_mfma_f32_32x32x16_bf16 v[64:79], a[48:51], v[32:35], v[64:79]
    ds_read_b64 v[48:49], v8 offset:36864
    ds_read_b64 v[50:51], v8 offset:37888
    s_add_u32 m0, s53, 83968
    s_add_u32 s56, s52, 81920
    buffer_load_dwordx4 v3, s[48:51], s56 offen lds
    s_waitcnt lgkmcnt(6)
    v_mfma_f32_32x32x16_bf16 v[80:95], a[48:51], v[36:39], v[80:95]
    ds_read_b64 v[52:53], v9 offset:36864
    ds_read_b64 v[54:55], v9 offset:37888
    s_add_u32 m0, s53, 84992
    s_add_u32 s56, s52, 82944
    buffer_load_dwordx4 v3, s[48:51], s56 offen lds
    s_waitcnt lgkmcnt(6)
    v_mfma_f32_32x32x16_bf16 v[96:111], a[48:51], v[40:43], v[96:111]
    ds_read_b64 v[56:57], v10 offset:36864
    ds_read_b64 v[58:59], v10 offset:37888
    s_add_u32 m0, s53, 86016
    s_add_u32 s56, s52, 83968
    buffer_load_dwordx4 v3, s[48:51], s56 offen lds
    s_waitcnt lgkmcnt(6)
    v_mfma_f32_32x32x16_bf16 v[112:127], a[48:51], v[44:47], v[112:127]
    ds_read_b64 v[60:61], v11 offset:36864
    ds_read_b64 v[62:63], v11 offset:37888
    s_add_u32 m0, s53, 87040
    s_add_u32 s56, s52, 84992
    buffer_load_dwordx4 v3, s[48:51], s56 offen lds
    s_waitcnt lgkmcnt(6)
    v_mfma_f32_32x32x16_bf16 v[64:79], a[52:55], v[48:51], v[64:79]
    ds_read_b64 v[32:33], v8 offset:40960
    ds_read_b64 v[34:35], v8 offset:41984
    s_add_u32 m0, s53, 88064
    s_add_u32 s56, s52, 86016
    buffer_load_dwordx4 v3, s[48:51], s56 offen lds
    s_waitcnt lgkmcnt(6)
    v_mfma_f32_32x32x16_bf16 v[80:95], a[52:55], v[52:55], v[80:95]
    ds_read_b64 v[36:37], v9 offset:40960
    ds_read_b64 v[38:39], v9 offset:41984
    s_add_u32 m0, s53, 104448
    s_add_u32 s56, s52, 102400
    buffer_load_dwordx4 v3, s[48:51], s56 offen lds
    s_waitcnt lgkmcnt(6)
    v_mfma_f32_32x32x16_bf16 v[96:111], a[52:55], v[56:59], v[96:111]
    ds_read_b64 v[40:41], v10 offset:40960
    ds_read_b64 v[42:43], v10 offset:41984
    s_add_u32 m0, s53, 105472
    s_add_u32 s56, s52, 103424
    buffer_load_dwordx4 v3, s[48:51], s56 offen lds
    s_waitcnt lgkmcnt(6)
    v_mfma_f32_32x32x16_bf16 v[112:127], a[52:55], v[60:63], v[112:127]
    ds_read_b64 v[44:45], v11 offset:40960
    ds_read_b64 v[46:47], v11 offset:41984
    s_add_u32 m0, s53, 106496
    s_add_u32 s56, s52, 104448
    buffer_load_dwordx4 v3, s[48:51], s56 offen lds
    s_waitcnt lgkmcnt(6)
    v_mfma_f32_32x32x16_bf16 v[64:79], a[56:59], v[32:35], v[64:79]
    ds_read_b64 v[48:49], v8 offset:45056
    ds_read_b64 v[50:51], v8 offset:46080
    s_add_u32 m0, s53, 107520
    s_add_u32 s56, s52, 105472
    buffer_load_dwordx4 v3, s[48:51], s56 offen lds
    s_waitcnt lgkmcnt(6)
    v_mfma_f32_32x32x16_bf16 v[80:95], a[56:59], v[36:39], v[80:95]
    ds_read_b64 v[52:53], v9 offset:45056
    ds_read_b64 v[54:55], v9 offset:46080
    s_add_u32 m0, s53, 108544
    s_add_u32 s56, s52, 106496
    buffer_load_dwordx4 v3, s[48:51], s56 offen lds
    s_waitcnt lgkmcnt(6)
    v_mfma_f32_32x32x16_bf16 v[96:111], a[56:59], v[40:43], v[96:111]
    ds_read_b64 v[56:57], v10 offset:45056
    ds_read_b64 v[58:59], v10 offset:46080
    s_add_u32 m0, s53, 124928
    s_add_u32 s56, s52, 122880
    buffer_load_dwordx4 v3, s[48:51], s56 offen lds
    s_waitcnt lgkmcnt(6)
    v_mfma_f32_32x32x16_bf16 v[112:127], a[56:59], v[44:47], v[112:127]
    ds_read_b64 v[60:61], v11 offset:45056
    ds_read_b64 v[62:63], v11 offset:46080
    s_add_u32 m0, s53, 125952
    s_add_u32 s56, s52, 123904
    buffer_load_dwordx4 v3, s[48:51], s56 offen lds
    s_waitcnt vmcnt(24)
    s_barrier
    s_waitcnt lgkmcnt(6)
    v_mfma_f32_32x32x16_bf16 v[64:79], a[60:63], v[48:51], v[64:79]
    ds_read_b64 v[32:33], v12 offset:0
    ds_read_b64 v[34:35], v12 offset:1024
    s_add_u32 m0, s53, 126976
    s_add_u32 s56, s52, 124928
    buffer_load_dwordx4 v3, s[48:51], s56 offen lds
    s_waitcnt lgkmcnt(6)
    v_mfma_f32_32x32x16_bf16 v[80:95], a[60:63], v[52:55], v[80:95]
    ds_read_b64 v[36:37], v13 offset:0
    ds_read_b64 v[38:39], v13 offset:1024
    s_add_u32 m0, s53, 128000
    s_add_u32 s56, s52, 125952
    buffer_load_dwordx4 v3, s[48:51], s56 offen lds
    s_waitcnt lgkmcnt(6)
    v_mfma_f32_32x32x16_bf16 v[96:111], a[60:63], v[56:59], v[96:111]
    ds_read_b64 v[40:41], v14 offset:0
    ds_read_b64 v[42:43], v14 offset:1024
    s_add_u32 m0, s53, 129024
    s_add_u32 s56, s52, 126976
    buffer_load_dwordx4 v3, s[48:51], s56 offen lds
    s_waitcnt lgkmcnt(6)
    v_mfma_f32_32x32x16_bf16 v[112:127], a[60:63], v[60:63], v[112:127]
    ds_read_b64 v[44:45], v15 offset:0
    ds_read_b64 v[46:47], v15 offset:1024
    s_waitcnt lgkmcnt(6)
    v_mfma_f32_32x32x16_bf16 v[64:79], a[0:3], v[32:35], v[64:79]
    ds_read_b64 v[48:49], v12 offset:4096
    ds_read_b64 v[50:51], v12 offset:5120
    s_waitcnt lgkmcnt(6)
    v_mfma_f32_32x32x16_bf16 v[80:95], a[0:3], v[36:39], v[80:95]
    ds_read_b64 v[52:53], v13 offset:4096
    ds_read_b64 v[54:55], v13 offset:5120
    s_waitcnt lgkmcnt(6)
    v_mfma_f32_32x32x16_bf16 v[96:111], a[0:3], v[40:43], v[96:111]
    ds_read_b64 v[56:57], v14 offset:4096
    ds_read_b64 v[58:59], v14 offset:5120
    s_waitcnt lgkmcnt(6)
    v_mfma_f32_32x32x16_bf16 v[112:127], a[0:3], v[44:47], v[112:127]
    ds_read_b64 v[60:61], v15 offset:4096
    ds_read_b64 v[62:63], v15 offset:5120
    s_waitcnt lgkmcnt(6)
    v_mfma_f32_32x32x16_bf16 v[64:79], a[4:7], v[48:51], v[64:79]
    ds_read_b64 v[32:33], v12 offset:8192
    ds_read_b64 v[34:35], v12 offset:9216
    s_waitcnt lgkmcnt(6)
    v_mfma_f32_32x32x16_bf16 v[80:95], a[4:7], v[52:55], v[80:95]
    ds_read_b64 v[36:37], v13 offset:8192
    ds_read_b64 v[38:39], v13 offset:9216
    s_waitcnt lgkmcnt(6)
    v_mfma_f32_32x32x16_bf16 v[96:111], a[4:7], v[56:59], v[96:111]
    ds_read_b64 v[40:41], v14 offset:8192
    ds_read_b64 v[42:43], v14 offset:9216
    s_waitcnt lgkmcnt(6)
    v_mfma_f32_32x32x16_bf16 v[112:127], a[4:7], v[60:63], v[112:127]
    ds_read_b64 v[44:45], v15 offset:8192
    ds_read_b64 v[46:47], v15 offset:9216
    s_waitcnt vmcnt(26)
    s_waitcnt lgkmcnt(6)
    v_mfma_f32_32x32x16_bf16 v[64:79], a[8:11], v[32:35], v[64:79]
    ds_read_b64 v[48:49], v12 offset:12288
    ds_read_b64 v[50:51], v12 offset:13312
    s_waitcnt lgkmcnt(6)
    v_mfma_f32_32x32x16_bf16 v[80:95], a[8:11], v[36:39], v[80:95]
    ds_read_b64 v[52:53], v13 offset:12288
    ds_read_b64 v[54:55], v13 offset:13312
    s_waitcnt lgkmcnt(6)
    v_mfma_f32_32x32x16_bf16 v[96:111], a[8:11], v[40:43], v[96:111]
    ds_read_b64 v[56:57], v14 offset:12288
    ds_read_b64 v[58:59], v14 offset:13312
    s_waitcnt lgkmcnt(6)
    v_mfma_f32_32x32x16_bf16 v[112:127], a[8:11], v[44:47], v[112:127]
    ds_read_b64 v[60:61], v15 offset:12288
    ds_read_b64 v[62:63], v15 offset:13312
    s_waitcnt vmcnt(21)
    s_barrier
    s_waitcnt lgkmcnt(6)
    v_mfma_f32_32x32x16_bf16 v[64:79], a[12:15], v[48:51], v[64:79]
    ds_read_b64 v[32:33], v12 offset:16384
    ds_read_b64 v[34:35], v12 offset:17408
    s_waitcnt lgkmcnt(6)
    v_mfma_f32_32x32x16_bf16 v[80:95], a[12:15], v[52:55], v[80:95]
    ds_read_b64 v[36:37], v13 offset:16384
    ds_read_b64 v[38:39], v13 offset:17408
    s_waitcnt lgkmcnt(6)
    v_mfma_f32_32x32x16_bf16 v[96:111], a[12:15], v[56:59], v[96:111]
    ds_read_b64 v[40:41], v14 offset:16384
    ds_read_b64 v[42:43], v14 offset:17408
    s_waitcnt lgkmcnt(6)
    v_mfma_f32_32x32x16_bf16 v[112:127], a[12:15], v[60:63], v[112:127]
    ds_read_b64 v[44:45], v15 offset:16384
    ds_read_b64 v[46:47], v15 offset:17408
    s_waitcnt lgkmcnt(6)
    v_mfma_f32_32x32x16_bf16 v[64:79], a[16:19], v[32:35], v[64:79]
    ds_read_b64 v[48:49], v12 offset:20480
    ds_read_b64 v[50:51], v12 offset:21504
    s_waitcnt lgkmcnt(6)
    v_mfma_f32_32x32x16_bf16 v[80:95], a[16:19], v[36:39], v[80:95]
    ds_read_b64 v[52:53], v13 offset:20480
    ds_read_b64 v[54:55], v13 offset:21504
    s_waitcnt lgkmcnt(6)
    v_mfma_f32_32x32x16_bf16 v[96:111], a[16:19], v[40:43], v[96:111]
    ds_read_b64 v[56:57], v14 offset:20480
    ds_read_b64 v[58:59], v14 offset:21504
    s_waitcnt lgkmcnt(6)
    v_mfma_f32_32x32x16_bf16 v[112:127], a[16:19], v[44:47], v[112:127]
    ds_read_b64 v[60:61], v15 offset:20480
    ds_read_b64 v[62:63], v15 offset:21504
    s_waitcnt lgkmcnt(6)
    v_mfma_f32_32x32x16_bf16 v[64:79], a[20:23], v[48:51], v[64:79]
    ds_read_b64 v[32:33], v12 offset:24576
    ds_read_b64 v[34:35], v12 offset:25600
    s_waitcnt lgkmcnt(6)
    v_mfma_f32_32x32x16_bf16 v[80:95], a[20:23], v[52:55], v[80:95]
    ds_read_b64 v[36:37], v13 offset:24576
    ds_read_b64 v[38:39], v13 offset:25600
    s_waitcnt lgkmcnt(6)
    v_mfma_f32_32x32x16_bf16 v[96:111], a[20:23], v[56:59], v[96:111]
    ds_read_b64 v[40:41], v14 offset:24576
    ds_read_b64 v[42:43], v14 offset:25600
    s_waitcnt lgkmcnt(6)
    v_mfma_f32_32x32x16_bf16 v[112:127], a[20:23], v[60:63], v[112:127]
    ds_read_b64 v[44:45], v15 offset:24576
    ds_read_b64 v[46:47], v15 offset:25600
    s_waitcnt vmcnt(20)
    s_waitcnt lgkmcnt(6)
    v_mfma_f32_32x32x16_bf16 v[64:79], a[24:27], v[32:35], v[64:79]
    ds_read_b64 v[48:49], v12 offset:28672
    ds_read_b64 v[50:51], v12 offset:29696
    s_waitcnt lgkmcnt(6)
    v_mfma_f32_32x32x16_bf16 v[80:95], a[24:27], v[36:39], v[80:95]
    ds_read_b64 v[52:53], v13 offset:28672
    ds_read_b64 v[54:55], v13 offset:29696
    s_waitcnt lgkmcnt(6)
    v_mfma_f32_32x32x16_bf16 v[96:111], a[24:27], v[40:43], v[96:111]
    ds_read_b64 v[56:57], v14 offset:28672
    ds_read_b64 v[58:59], v14 offset:29696
    s_waitcnt lgkmcnt(6)
    v_mfma_f32_32x32x16_bf16 v[112:127], a[24:27], v[44:47], v[112:127]
    ds_read_b64 v[60:61], v15 offset:28672
    ds_read_b64 v[62:63], v15 offset:29696
    s_waitcnt vmcnt(16)
    s_waitcnt lgkmcnt(6)
    v_mfma_f32_32x32x16_bf16 v[64:79], a[28:31], v[48:51], v[64:79]
    s_waitcnt lgkmcnt(4)
    v_mfma_f32_32x32x16_bf16 v[80:95], a[28:31], v[52:55], v[80:95]
    s_waitcnt lgkmcnt(2)
    v_mfma_f32_32x32x16_bf16 v[96:111], a[28:31], v[56:59], v[96:111]
    s_waitcnt lgkmcnt(0)
    v_mfma_f32_32x32x16_bf16 v[112:127], a[28:31], v[60:63], v[112:127]
    s_waitcnt vmcnt(15)
k3_t2:
    s_lshl_b32 s63, s33, 8
    s_lshl_b32 s3, s34, 4
    s_add_u32 s63, s63, s3
    s_lshr_b32 s3, s32, 2
    s_mul_i32 s6, s3, 10240
    s_lshl_b32 s7, s53, 2
    s_add_u32 s6, s6, s7
    s_mul_i32 s3, s3, 40960
    s_add_u32 s3, s3, s52
    s_barrier
    s_add_u32 m0, s6, 0
    s_add_u32 s56, s3, 143360
    buffer_load_dwordx4 v3, s[48:51], s56 offen lds
    s_add_u32 m0, s6, 1024
    s_add_u32 s56, s3, 144384
    buffer_load_dwordx4 v3, s[48:51], s56 offen lds
    s_add_u32 m0, s6, 2048
    s_add_u32 s56, s3, 145408
    buffer_load_dwordx4 v3, s[48:51], s56 offen lds
    s_add_u32 m0, s6, 3072
    s_add_u32 s56, s3, 146432
    buffer_load_dwordx4 v3, s[48:51], s56 offen lds
    s_add_u32 m0, s6, 4096
    s_add_u32 s56, s3, 147456
    buffer_load_dwordx4 v3, s[48:51], s56 offen lds
    s_add_u32 m0, s6, 5120
    s_add_u32 s56, s3, 163840
    buffer_load_dwordx4 v3, s[48:51], s56 offen lds
    s_add_u32 m0, s6, 6144
    s_add_u32 s56, s3, 164864
    buffer_load_dwordx4 v3, s[48:51], s56 offen lds
    s_add_u32 m0, s6, 7168
    s_add_u32 s56, s3, 165888
    buffer_load_dwordx4 v3, s[48:51], s56 offen lds
    s_add_u32 m0, s6, 8192
    s_add_u32 s56, s3, 166912
    buffer_load_dwordx4 v3, s[48:51], s56 offen lds
    s_add_u32 m0, s6, 9216
    s_add_u32 s56, s3, 167936
    buffer_load_dwordx4 v3, s[48:51], s56 offen lds
    s_cmp_ge_u32 s35, 108
    s_cbranch_scc1 k4_in
    s_lshl_b32 s7, s32, 7
    s_add_u32 s7, s7, 81920
    v_lshlrev_b32 v4, 4, v6
    v_add_u32 v4, s7, v4
    ds_read_b128 v[32:35], v4 offset:0
    ds_read_b128 v[48:51], v4 offset:1024
    ds_read_b128 v[36:39], v4 offset:32
    ds_read_b128 v[52:55], v4 offset:1056
    ds_read_b128 v[40:43], v4 offset:64
    ds_read_b128 v[56:59], v4 offset:1088
    ds_read_b128 v[44:47], v4 offset:96
    ds_read_b128 v[60:63], v4 offset:1120
    v_lshlrev_b32 v7, 15, v6
    v_lshl_add_u32 v7, v5, 4, v7
    s_lshl_b32 s35, s35, 16
    s_lshl_b32 s33, s33, 11
    s_add_u32 s35, s35, s33
    s_mov_b32 s44, 0xbfb8aa3b
    s_mov_b32 s45, 0xbfb8aa3b
    s_waitcnt lgkmcnt(0)
    v_pk_fma_f32 v[8:9], v[32:33], v[16:17], v[48:49] op_sel_hi:[1,0,1]
    v_pk_fma_f32 v[10:11], v[36:37], v[16:17], v[52:53] op_sel_hi:[1,0,1]
    v_pk_fma_f32 v[64:65], v[64:65], v[16:17], v[8:9] op_sel:[0,1,0]
    v_pk_fma_f32 v[68:69], v[68:69], v[16:17], v[10:11] op_sel:[0,1,0]
    v_pk_mul_f32 v[8:9], v[64:65], s[44:45]
    v_pk_mul_f32 v[68:69], v[68:69], v[64:65]
    v_exp_f32 v8, v8
    v_exp_f32 v9, v9
    v_pk_fma_f32 v[12:13], v[34:35], v[16:17], v[50:51] op_sel_hi:[1,0,1]
    v_pk_fma_f32 v[14:15], v[38:39], v[16:17], v[54:55] op_sel_hi:[1,0,1]
    v_pk_fma_f32 v[66:67], v[66:67], v[16:17], v[12:13] op_sel:[0,1,0]
    v_pk_fma_f32 v[70:71], v[70:71], v[16:17], v[14:15] op_sel:[0,1,0]
    v_pk_mul_f32 v[12:13], v[66:67], s[44:45]
    v_pk_mul_f32 v[70:71], v[70:71], v[66:67]
    v_exp_f32 v12, v12
    v_exp_f32 v13, v13
    v_pk_add_f32 v[8:9], v[8:9], 1.0 op_sel_hi:[1,0]
    v_rcp_f32 v8, v8
    v_rcp_f32 v9, v9
    v_pk_add_f32 v[12:13], v[12:13], 1.0 op_sel_hi:[1,0]
    v_rcp_f32 v12, v12
    v_rcp_f32 v13, v13
    v_pk_mul_f32 v[68:69], v[68:69], v[8:9]
    v_cvt_pk_bf16_f32 v24, v68, v69
    v_pk_mul_f32 v[70:71], v[70:71], v[12:13]
    v_cvt_pk_bf16_f32 v25, v70, v71
    v_pk_fma_f32 v[8:9], v[40:41], v[16:17], v[56:57] op_sel_hi:[1,0,1]
    v_pk_fma_f32 v[10:11], v[44:45], v[16:17], v[60:61] op_sel_hi:[1,0,1]
    v_pk_fma_f32 v[72:73], v[72:73], v[16:17], v[8:9] op_sel:[0,1,0]
    v_pk_fma_f32 v[76:77], v[76:77], v[16:17], v[10:11] op_sel:[0,1,0]
    v_pk_mul_f32 v[8:9], v[72:73], s[44:45]
    v_pk_mul_f32 v[76:77], v[76:77], v[72:73]
    v_exp_f32 v8, v8
    v_exp_f32 v9, v9
    v_pk_fma_f32 v[12:13], v[42:43], v[16:17], v[58:59] op_sel_hi:[1,0,1]
    v_pk_fma_f32 v[14:15], v[46:47], v[16:17], v[62:63] op_sel_hi:[1,0,1]
    v_pk_fma_f32 v[74:75], v[74:75], v[16:17], v[12:13] op_sel:[0,1,0]
    v_pk_fma_f32 v[78:79], v[78:79], v[16:17], v[14:15] op_sel:[0,1,0]
    v_pk_mul_f32 v[12:13], v[74:75], s[44:45]
    v_pk_mul_f32 v[78:79], v[78:79], v[74:75]
    v_exp_f32 v12, v12
    v_exp_f32 v13, v13
    v_pk_add_f32 v[8:9], v[8:9], 1.0 op_sel_hi:[1,0]
    v_rcp_f32 v8, v8
    v_rcp_f32 v9, v9
    v_pk_add_f32 v[12:13], v[12:13], 1.0 op_sel_hi:[1,0]
    v_rcp_f32 v12, v12
    v_rcp_f32 v13, v13
    v_pk_mul_f32 v[76:77], v[76:77], v[8:9]
    v_cvt_pk_bf16_f32 v26, v76, v77
    v_pk_mul_f32 v[78:79], v[78:79], v[12:13]
    v_cvt_pk_bf16_f32 v27, v78, v79
    s_lshl_b32 s7, s40, 9
    s_add_u32 s7, s7, s35
    buffer_store_dwordx4 v[24:27], v7, s[20:23], s7 offen sc1
    v_pk_fma_f32 v[8:9], v[32:33], v[18:19], v[48:49] op_sel_hi:[1,0,1]
    v_pk_fma_f32 v[10:11], v[36:37], v[18:19], v[52:53] op_sel_hi:[1,0,1]
    v_pk_fma_f32 v[80:81], v[80:81], v[18:19], v[8:9] op_sel:[0,1,0]
    v_pk_fma_f32 v[84:85], v[84:85], v[18:19], v[10:11] op_sel:[0,1,0]
    v_pk_mul_f32 v[8:9], v[80:81], s[44:45]
    v_pk_mul_f32 v[84:85], v[84:85], v[80:81]
    v_exp_f32 v8, v8
    v_exp_f32 v9, v9
    v_pk_fma_f32 v[12:13], v[34:35], v[18:19], v[50:51] op_sel_hi:[1,0,1]
    v_pk_fma_f32 v[14:15], v[38:39], v[18:19], v[54:55] op_sel_hi:[1,0,1]
    v_pk_fma_f32 v[82:83], v[82:83], v[18:19], v[12:13] op_sel:[0,1,0]
    v_pk_fma_f32 v[86:87], v[86:87], v[18:19], v[14:15] op_sel:[0,1,0]
    v_pk_mul_f32 v[12:13], v[82:83], s[44:45]
    v_pk_mul_f32 v[86:87], v[86:87], v[82:83]
    v_exp_f32 v12, v12
    v_exp_f32 v13, v13
    v_pk_add_f32 v[8:9], v[8:9], 1.0 op_sel_hi:[1,0]
    v_rcp_f32 v8, v8
    v_rcp_f32 v9, v9
    v_pk_add_f32 v[12:13], v[12:13], 1.0 op_sel_hi:[1,0]
    v_rcp_f32 v12, v12
    v_rcp_f32 v13, v13
    v_pk_mul_f32 v[84:85], v[84:85], v[8:9]
    v_cvt_pk_bf16_f32 v28, v84, v85
    v_pk_mul_f32 v[86:87], v[86:87], v[12:13]
    v_cvt_pk_bf16_f32 v29, v86, v87
    v_pk_fma_f32 v[8:9], v[40:41], v[18:19], v[56:57] op_sel_hi:[1,0,1]
    v_pk_fma_f32 v[10:11], v[44:45], v[18:19], v[60:61] op_sel_hi:[1,0,1]
    v_pk_fma_f32 v[88:89], v[88:89], v[18:19], v[8:9] op_sel:[0,1,0]
    v_pk_fma_f32 v[92:93], v[92:93], v[18:19], v[10:11] op_sel:[0,1,0]
    v_pk_mul_f32 v[8:9], v[88:89], s[44:45]
    v_pk_mul_f32 v[92:93], v[92:93], v[88:89]
    v_exp_f32 v8, v8
    v_exp_f32 v9, v9
    v_pk_fma_f32 v[12:13], v[42:43], v[18:19], v[58:59] op_sel_hi:[1,0,1]
    v_pk_fma_f32 v[14:15], v[46:47], v[18:19], v[62:63] op_sel_hi:[1,0,1]
    v_pk_fma_f32 v[90:91], v[90:91], v[18:19], v[12:13] op_sel:[0,1,0]
    v_pk_fma_f32 v[94:95], v[94:95], v[18:19], v[14:15] op_sel:[0,1,0]
    v_pk_mul_f32 v[12:13], v[90:91], s[44:45]
    v_pk_mul_f32 v[94:95], v[94:95], v[90:91]
    v_exp_f32 v12, v12
    v_exp_f32 v13, v13
    v_pk_add_f32 v[8:9], v[8:9], 1.0 op_sel_hi:[1,0]
    v_rcp_f32 v8, v8
    v_rcp_f32 v9, v9
    v_pk_add_f32 v[12:13], v[12:13], 1.0 op_sel_hi:[1,0]
    v_rcp_f32 v12, v12
    v_rcp_f32 v13, v13
    v_pk_mul_f32 v[92:93], v[92:93], v[8:9]
    v_cvt_pk_bf16_f32 v30, v92, v93
    v_pk_mul_f32 v[94:95], v[94:95], v[12:13]
    v_cvt_pk_bf16_f32 v31, v94, v95
    s_lshl_b32 s7, s41, 9
    s_add_u32 s7, s7, s35
    buffer_store_dwordx4 v[28:31], v7, s[20:23], s7 offen sc1
    v_pk_fma_f32 v[8:9], v[32:33], v[20:21], v[48:49] op_sel_hi:[1,0,1]
    v_pk_fma_f32 v[10:11], v[36:37], v[20:21], v[52:53] op_sel_hi:[1,0,1]
    v_pk_fma_f32 v[96:97], v[96:97], v[20:21], v[8:9] op_sel:[0,1,0]
    v_pk_fma_f32 v[100:101], v[100:101], v[20:21], v[10:11] op_sel:[0,1,0]
    v_pk_mul_f32 v[8:9], v[96:97], s[44:45]
    v_pk_mul_f32 v[100:101], v[100:101], v[96:97]
    v_exp_f32 v8, v8
    v_exp_f32 v9, v9
    v_pk_fma_f32 v[12:13], v[34:35], v[20:21], v[50:51] op_sel_hi:[1,0,1]
    v_pk_fma_f32 v[14:15], v[38:39], v[20:21], v[54:55] op_sel_hi:[1,0,1]
    v_pk_fma_f32 v[98:99], v[98:99], v[20:21], v[12:13] op_sel:[0,1,0]
    v_pk_fma_f32 v[102:103], v[102:103], v[20:21], v[14:15] op_sel:[0,1,0]
    v_pk_mul_f32 v[12:13], v[98:99], s[44:45]
    v_pk_mul_f32 v[102:103], v[102:103], v[98:99]
    v_exp_f32 v12, v12
    v_exp_f32 v13, v13
    v_pk_add_f32 v[8:9], v[8:9], 1.0 op_sel_hi:[1,0]
    v_rcp_f32 v8, v8
    v_rcp_f32 v9, v9
    v_pk_add_f32 v[12:13], v[12:13], 1.0 op_sel_hi:[1,0]
    v_rcp_f32 v12, v12
    v_rcp_f32 v13, v13
    v_pk_mul_f32 v[100:101], v[100:101], v[8:9]
    v_cvt_pk_bf16_f32 v24, v100, v101
    v_pk_mul_f32 v[102:103], v[102:103], v[12:13]
    v_cvt_pk_bf16_f32 v25, v102, v103
    v_pk_fma_f32 v[8:9], v[40:41], v[20:21], v[56:57] op_sel_hi:[1,0,1]
    v_pk_fma_f32 v[10:11], v[44:45], v[20:21], v[60:61] op_sel_hi:[1,0,1]
    v_pk_fma_f32 v[104:105], v[104:105], v[20:21], v[8:9] op_sel:[0,1,0]
    v_pk_fma_f32 v[108:109], v[108:109], v[20:21], v[10:11] op_sel:[0,1,0]
    v_pk_mul_f32 v[8:9], v[104:105], s[44:45]
    v_pk_mul_f32 v[108:109], v[108:109], v[104:105]
    v_exp_f32 v8, v8
    v_exp_f32 v9, v9
    v_pk_fma_f32 v[12:13], v[42:43], v[20:21], v[58:59] op_sel_hi:[1,0,1]
    v_pk_fma_f32 v[14:15], v[46:47], v[20:21], v[62:63] op_sel_hi:[1,0,1]
    v_pk_fma_f32 v[106:107], v[106:107], v[20:21], v[12:13] op_sel:[0,1,0]
    v_pk_fma_f32 v[110:111], v[110:111], v[20:21], v[14:15] op_sel:[0,1,0]
    v_pk_mul_f32 v[12:13], v[106:107], s[44:45]
    v_pk_mul_f32 v[110:111], v[110:111], v[106:107]
    v_exp_f32 v12, v12
    v_exp_f32 v13, v13
    v_pk_add_f32 v[8:9], v[8:9], 1.0 op_sel_hi:[1,0]
    v_rcp_f32 v8, v8
    v_rcp_f32 v9, v9
    v_pk_add_f32 v[12:13], v[12:13], 1.0 op_sel_hi:[1,0]
    v_rcp_f32 v12, v12
    v_rcp_f32 v13, v13
    v_pk_mul_f32 v[108:109], v[108:109], v[8:9]
    v_cvt_pk_bf16_f32 v26, v108, v109
    v_pk_mul_f32 v[110:111], v[110:111], v[12:13]
    v_cvt_pk_bf16_f32 v27, v110, v111
    s_lshl_b32 s7, s42, 9
    s_add_u32 s7, s7, s35
    buffer_store_dwordx4 v[24:27], v7, s[20:23], s7 offen sc1
    v_pk_fma_f32 v[8:9], v[32:33], v[22:23], v[48:49] op_sel_hi:[1,0,1]
    v_pk_fma_f32 v[10:11], v[36:37], v[22:23], v[52:53] op_sel_hi:[1,0,1]
    v_pk_fma_f32 v[112:113], v[112:113], v[22:23], v[8:9] op_sel:[0,1,0]
    v_pk_fma_f32 v[116:117], v[116:117], v[22:23], v[10:11] op_sel:[0,1,0]
    v_pk_mul_f32 v[8:9], v[112:113], s[44:45]
    v_pk_mul_f32 v[116:117], v[116:117], v[112:113]
    v_exp_f32 v8, v8
    v_exp_f32 v9, v9
    v_pk_fma_f32 v[12:13], v[34:35], v[22:23], v[50:51] op_sel_hi:[1,0,1]
    v_pk_fma_f32 v[14:15], v[38:39], v[22:23], v[54:55] op_sel_hi:[1,0,1]
    v_pk_fma_f32 v[114:115], v[114:115], v[22:23], v[12:13] op_sel:[0,1,0]
    v_pk_fma_f32 v[118:119], v[118:119], v[22:23], v[14:15] op_sel:[0,1,0]
    v_pk_mul_f32 v[12:13], v[114:115], s[44:45]
    v_pk_mul_f32 v[118:119], v[118:119], v[114:115]
    v_exp_f32 v12, v12
    v_exp_f32 v13, v13
    v_pk_add_f32 v[8:9], v[8:9], 1.0 op_sel_hi:[1,0]
    v_rcp_f32 v8, v8
    v_rcp_f32 v9, v9
    v_pk_add_f32 v[12:13], v[12:13], 1.0 op_sel_hi:[1,0]
    v_rcp_f32 v12, v12
    v_rcp_f32 v13, v13
    v_pk_mul_f32 v[116:117], v[116:117], v[8:9]
    v_cvt_pk_bf16_f32 v28, v116, v117
    v_pk_mul_f32 v[118:119], v[118:119], v[12:13]
    v_cvt_pk_bf16_f32 v29, v118, v119
    v_pk_fma_f32 v[8:9], v[40:41], v[22:23], v[56:57] op_sel_hi:[1,0,1]
    v_pk_fma_f32 v[10:11], v[44:45], v[22:23], v[60:61] op_sel_hi:[1,0,1]
    v_pk_fma_f32 v[120:121], v[120:121], v[22:23], v[8:9] op_sel:[0,1,0]
    v_pk_fma_f32 v[124:125], v[124:125], v[22:23], v[10:11] op_sel:[0,1,0]
    v_pk_mul_f32 v[8:9], v[120:121], s[44:45]
    v_pk_mul_f32 v[124:125], v[124:125], v[120:121]
    v_exp_f32 v8, v8
    v_exp_f32 v9, v9
    v_pk_fma_f32 v[12:13], v[42:43], v[22:23], v[58:59] op_sel_hi:[1,0,1]
    v_pk_fma_f32 v[14:15], v[46:47], v[22:23], v[62:63] op_sel_hi:[1,0,1]
    v_pk_fma_f32 v[122:123], v[122:123], v[22:23], v[12:13] op_sel:[0,1,0]
    v_pk_fma_f32 v[126:127], v[126:127], v[22:23], v[14:15] op_sel:[0,1,0]
    v_pk_mul_f32 v[12:13], v[122:123], s[44:45]
    v_pk_mul_f32 v[126:127], v[126:127], v[122:123]
    v_exp_f32 v12, v12
    v_exp_f32 v13, v13
    v_pk_add_f32 v[8:9], v[8:9], 1.0 op_sel_hi:[1,0]
    v_rcp_f32 v8, v8
    v_rcp_f32 v9, v9
    v_pk_add_f32 v[12:13], v[12:13], 1.0 op_sel_hi:[1,0]
    v_rcp_f32 v12, v12
    v_rcp_f32 v13, v13
    v_pk_mul_f32 v[124:125], v[124:125], v[8:9]
    v_cvt_pk_bf16_f32 v30, v124, v125
    v_pk_mul_f32 v[126:127], v[126:127], v[12:13]
    v_cvt_pk_bf16_f32 v31, v126, v127
    s_lshl_b32 s7, s43, 9
    s_add_u32 s7, s7, s35
    buffer_store_dwordx4 v[28:31], v7, s[20:23], s7 offen sc1
k4_in:
    s_load_dwordx2 s[24:25], s[0:1], 104
    s_add_u32 s64, s4, 118784
    s_addc_u32 s65, s5, 0
    s_mov_b32 s66, 4096
    s_mov_b32 s67, 0x00020000
    s_waitcnt vmcnt(0)
    s_barrier
    s_cmp_ge_u32 s32, 4
    s_cbranch_scc1 k4_wm
    s_cmp_lg_u32 s32, 0
    s_cbranch_scc1 k4_ns
    s_cmp_lt_u32 s62, 32
    s_cbranch_scc1 k4_ns
    v_mov_b32 v8, 0
    v_mov_b32 v9, 1
    s_mov_b64 exec, 1
    buffer_store_dword v9, v8, s[64:67], s63 offen sc1
    s_mov_b64 exec, -1
k4_ns:
    s_mov_b32 s33, s54
    s_mov_b32 s34, s55
    s_lshl_b32 s36, s32, 17
    s_lshl_b32 s3, s33, 10
    s_add_u32 s36, s36, s3
    v_and_b32 v1, 63, v0
    s_lshl_b32 s7, s53, 2
    v_add_u32 v2, s7, v3
    s_add_u32 s53, s53, 83968
    v_add_u32 v4, s53, v3
    v_and_b32 v5, 15, v1
    v_lshrrev_b32 v6, 4, v1
    v_lshlrev_b32 v7, 15, v6
    v_lshl_add_u32 v7, v5, 4, v7
    s_waitcnt lgkmcnt(0)
    s_add_u32 s8, s4, 18874368
    s_addc_u32 s9, s5, 0
    s_mov_b32 s10, 7077888
    s_mov_b32 s11, 0x00020000
    s_add_u32 s16, s4, 0
    s_addc_u32 s17, s5, 0
    s_mov_b32 s18, 30720
    s_mov_b32 s19, 0x00020000
    s_add_u32 s20, s4, 1048576
    s_addc_u32 s21, s5, 0
    s_mov_b32 s22, 2621440
    s_mov_b32 s23, 0x00020000
    s_mov_b32 s26, 2621440
    s_mov_b32 s27, 0x00020000
    v_lshlrev_b32 v12, 2, v0
    s_mul_i32 s3, s34, 320
    s_add_u32 s3, s3, 12800
    buffer_load_dword v16, v12, s[16:19], s3 offen
    s_add_u32 s3, s3, 15360
    buffer_load_dword v17, v12, s[16:19], s3 offen
    s_add_u32 s3, s3, 15360
    v_mul_u32_u24 v13, 81920, v6
    v_lshl_add_u32 v13, v5, 3, v13
    s_mul_i32 s3, s34, 327680
    s_lshl_b32 s6, s33, 9
    s_add_u32 s3, s3, s6
    s_lshl_b32 s6, s32, 7
    s_add_u32 s3, s3, s6
    buffer_load_dwordx2 v[20:21], v13, s[20:23], s3 offen
    s_add_u32 s3, s3, 16384
    buffer_load_dwordx2 v[22:23], v13, s[20:23], s3 offen
    s_add_u32 s3, s3, 16384
    buffer_load_dwordx2 v[24:25], v13, s[20:23], s3 offen
    s_add_u32 s3, s3, 16384
    buffer_load_dwordx2 v[26:27], v13, s[20:23], s3 offen
    s_add_u32 s3, s3, 16384
    buffer_load_dwordx2 v[28:29], v13, s[20:23], s3 offen
    s_add_u32 s3, s3, 16384
    s_cmp_lg_u32 s32, 0
    s_cbranch_scc1 k4_p_ok
    v_min_u32 v8, 13, v1
    v_lshlrev_b32 v8, 4, v8
    s_lshr_b32 s3, s33, 1
    s_lshl_b32 s3, s3, 8
    v_add_u32 v8, s3, v8
k4_p:
    buffer_load_dword v9, v8, s[64:67], 0 offen offset:0 sc1
    s_waitcnt vmcnt(0)
    v_cmp_eq_u32 vcc, 1, v9
    s_nop 4
    s_cmp_eq_u64 vcc, -1
    s_cbranch_scc1 k4_p_ok
    s_sleep 4
    s_branch k4_p
k4_p_ok:
    s_barrier
    s_xor_b32 s7, s32, 0
    s_lshl_b32 s7, s7, 8
    v_add_u32 v8, s7, v7
    s_xor_b32 s7, s32, 1
    s_lshl_b32 s7, s7, 8
    v_add_u32 v9, s7, v7
    s_xor_b32 s7, s32, 2
    s_lshl_b32 s7, s7, 8
    v_add_u32 v10, s7, v7
    s_xor_b32 s7, s32, 3
    s_lshl_b32 s7, s7, 8
    v_add_u32 v11, s7, v7
    buffer_load_dwordx4 a[0:3], v8, s[8:11], s36 offen sc1
    buffer_load_dwordx4 a[4:7], v9, s[8:11], s36 offen sc1
    buffer_load_dwordx4 a[8:11], v10, s[8:11], s36 offen sc1
    buffer_load_dwordx4 a[12:15], v11, s[8:11], s36 offen sc1
    s_add_u32 s36, s36, 524288
    buffer_load_dwordx4 a[16:19], v8, s[8:11], s36 offen sc1
    buffer_load_dwordx4 a[20:23], v9, s[8:11], s36 offen sc1
    buffer_load_dwordx4 a[24:27], v10, s[8:11], s36 offen sc1
    buffer_load_dwordx4 a[28:31], v11, s[8:11], s36 offen sc1
    s_add_u32 s36, s36, 524288
    buffer_load_dwordx4 a[48:51], v8, s[8:11], s36 offen sc1
    buffer_load_dwordx4 a[52:55], v9, s[8:11], s36 offen sc1
    buffer_load_dwordx4 a[56:59], v10, s[8:11], s36 offen sc1
    buffer_load_dwordx4 a[60:63], v11, s[8:11], s36 offen sc1
    s_add_u32 s36, s36, 524288
    buffer_load_dwordx4 v[112:115], v8, s[8:11], s36 offen sc1
    buffer_load_dwordx4 v[116:119], v9, s[8:11], s36 offen sc1
    buffer_load_dwordx4 v[120:123], v10, s[8:11], s36 offen sc1
    buffer_load_dwordx4 v[124:127], v11, s[8:11], s36 offen sc1
    s_add_u32 s36, s36, 524288
    s_waitcnt vmcnt(15)
    v_mfma_f32_16x16x32_bf16 v[32:35], a[32:35], a[0:3], 0
    v_mfma_f32_16x16x32_bf16 v[36:39], a[36:39], a[0:3], 0
    v_mfma_f32_16x16x32_bf16 v[40:43], a[40:43], a[0:3], 0
    v_mfma_f32_16x16x32_bf16 v[44:47], a[44:47], a[0:3], 0
    v_mfma_f32_16x16x32_bf16 v[48:51], a[64:67], a[0:3], 0
    s_waitcnt vmcnt(14)
    v_mfma_f32_16x16x32_bf16 v[52:55], a[32:35], a[4:7], 0
    v_mfma_f32_16x16x32_bf16 v[56:59], a[36:39], a[4:7], 0
    v_mfma_f32_16x16x32_bf16 v[60:63], a[40:43], a[4:7], 0
    v_mfma_f32_16x16x32_bf16 v[64:67], a[44:47], a[4:7], 0
    v_mfma_f32_16x16x32_bf16 v[68:71], a[64:67], a[4:7], 0
    s_waitcnt vmcnt(13)
    v_mfma_f32_16x16x32_bf16 v[72:75], a[32:35], a[8:11], 0
    v_mfma_f32_16x16x32_bf16 v[76:79], a[36:39], a[8:11], 0
    v_mfma_f32_16x16x32_bf16 v[80:83], a[40:43], a[8:11], 0
    v_mfma_f32_16x16x32_bf16 v[84:87], a[44:47], a[8:11], 0
    v_mfma_f32_16x16x32_bf16 v[88:91], a[64:67], a[8:11], 0
    s_waitcnt vmcnt(12)
    v_mfma_f32_16x16x32_bf16 v[92:95], a[32:35], a[12:15], 0
    v_mfma_f32_16x16x32_bf16 v[96:99], a[36:39], a[12:15], 0
    v_mfma_f32_16x16x32_bf16 v[100:103], a[40:43], a[12:15], 0
    v_mfma_f32_16x16x32_bf16 v[104:107], a[44:47], a[12:15], 0
    v_mfma_f32_16x16x32_bf16 v[108:111], a[64:67], a[12:15], 0
    ds_read_b128 a[32:35], v4 offset:0
    ds_read_b128 a[36:39], v4 offset:1024
    ds_read_b128 a[40:43], v4 offset:2048
    ds_read_b128 a[44:47], v4 offset:3072
    ds_read_b128 a[64:67], v4 offset:4096
    buffer_load_dwordx4 a[0:3], v8, s[8:11], s36 offen sc1
    buffer_load_dwordx4 a[4:7], v9, s[8:11], s36 offen sc1
    buffer_load_dwordx4 a[8:11], v10, s[8:11], s36 offen sc1
    buffer_load_dwordx4 a[12:15], v11, s[8:11], s36 offen sc1
    s_add_u32 s36, s36, 524288
    s_waitcnt vmcnt(15)
    v_mfma_f32_16x16x32_bf16 v[32:35], a[68:71], a[16:19], v[32:35]
    v_mfma_f32_16x16x32_bf16 v[36:39], a[72:75], a[16:19], v[36:39]
    v_mfma_f32_16x16x32_bf16 v[40:43], a[76:79], a[16:19], v[40:43]
    v_mfma_f32_16x16x32_bf16 v[44:47], a[80:83], a[16:19], v[44:47]
    v_mfma_f32_16x16x32_bf16 v[48:51], a[84:87], a[16:19], v[48:51]
    s_waitcnt vmcnt(14)
    v_mfma_f32_16x16x32_bf16 v[52:55], a[68:71], a[20:23], v[52:55]
    v_mfma_f32_16x16x32_bf16 v[56:59], a[72:75], a[20:23], v[56:59]
    v_mfma_f32_16x16x32_bf16 v[60:63], a[76:79], a[20:23], v[60:63]
    v_mfma_f32_16x16x32_bf16 v[64:67], a[80:83], a[20:23], v[64:67]
    v_mfma_f32_16x16x32_bf16 v[68:71], a[84:87], a[20:23], v[68:71]
    s_waitcnt vmcnt(13)
    v_mfma_f32_16x16x32_bf16 v[72:75], a[68:71], a[24:27], v[72:75]
    v_mfma_f32_16x16x32_bf16 v[76:79], a[72:75], a[24:27], v[76:79]
    v_mfma_f32_16x16x32_bf16 v[80:83], a[76:79], a[24:27], v[80:83]
    v_mfma_f32_16x16x32_bf16 v[84:87], a[80:83], a[24:27], v[84:87]
    v_mfma_f32_16x16x32_bf16 v[88:91], a[84:87], a[24:27], v[88:91]
    s_waitcnt vmcnt(12)
    v_mfma_f32_16x16x32_bf16 v[92:95], a[68:71], a[28:31], v[92:95]
    v_mfma_f32_16x16x32_bf16 v[96:99], a[72:75], a[28:31], v[96:99]
    v_mfma_f32_16x16x32_bf16 v[100:103], a[76:79], a[28:31], v[100:103]
    v_mfma_f32_16x16x32_bf16 v[104:107], a[80:83], a[28:31], v[104:107]
    v_mfma_f32_16x16x32_bf16 v[108:111], a[84:87], a[28:31], v[108:111]
    ds_read_b128 a[68:71], v4 offset:20480
    ds_read_b128 a[72:75], v4 offset:21504
    ds_read_b128 a[76:79], v4 offset:22528
    ds_read_b128 a[80:83], v4 offset:23552
    ds_read_b128 a[84:87], v4 offset:24576
    buffer_load_dwordx4 a[16:19], v8, s[8:11], s36 offen sc1
    buffer_load_dwordx4 a[20:23], v9, s[8:11], s36 offen sc1
    buffer_load_dwordx4 a[24:27], v10, s[8:11], s36 offen sc1
    buffer_load_dwordx4 a[28:31], v11, s[8:11], s36 offen sc1
    s_add_u32 s36, s36, 524288
    s_waitcnt vmcnt(15)
    v_mfma_f32_16x16x32_bf16 v[32:35], a[88:91], a[48:51], v[32:35]
    v_mfma_f32_16x16x32_bf16 v[36:39], a[92:95], a[48:51], v[36:39]
    v_mfma_f32_16x16x32_bf16 v[40:43], a[96:99], a[48:51], v[40:43]
    v_mfma_f32_16x16x32_bf16 v[44:47], a[100:103], a[48:51], v[44:47]
    v_mfma_f32_16x16x32_bf16 v[48:51], a[104:107], a[48:51], v[48:51]
    s_waitcnt vmcnt(14)
    v_mfma_f32_16x16x32_bf16 v[52:55], a[88:91], a[52:55], v[52:55]
    v_mfma_f32_16x16x32_bf16 v[56:59], a[92:95], a[52:55], v[56:59]
    v_mfma_f32_16x16x32_bf16 v[60:63], a[96:99], a[52:55], v[60:63]
    v_mfma_f32_16x16x32_bf16 v[64:67], a[100:103], a[52:55], v[64:67]
    v_mfma_f32_16x16x32_bf16 v[68:71], a[104:107], a[52:55], v[68:71]
    s_waitcnt vmcnt(13)
    v_mfma_f32_16x16x32_bf16 v[72:75], a[88:91], a[56:59], v[72:75]
    v_mfma_f32_16x16x32_bf16 v[76:79], a[92:95], a[56:59], v[76:79]
    v_mfma_f32_16x16x32_bf16 v[80:83], a[96:99], a[56:59], v[80:83]
    v_mfma_f32_16x16x32_bf16 v[84:87], a[100:103], a[56:59], v[84:87]
    v_mfma_f32_16x16x32_bf16 v[88:91], a[104:107], a[56:59], v[88:91]
    s_waitcnt vmcnt(12)
    v_mfma_f32_16x16x32_bf16 v[92:95], a[88:91], a[60:63], v[92:95]
    v_mfma_f32_16x16x32_bf16 v[96:99], a[92:95], a[60:63], v[96:99]
    v_mfma_f32_16x16x32_bf16 v[100:103], a[96:99], a[60:63], v[100:103]
    v_mfma_f32_16x16x32_bf16 v[104:107], a[100:103], a[60:63], v[104:107]
    v_mfma_f32_16x16x32_bf16 v[108:111], a[104:107], a[60:63], v[108:111]
    ds_read_b128 a[88:91], v4 offset:40960
    ds_read_b128 a[92:95], v4 offset:41984
    ds_read_b128 a[96:99], v4 offset:43008
    ds_read_b128 a[100:103], v4 offset:44032
    ds_read_b128 a[104:107], v4 offset:45056
    buffer_load_dwordx4 a[48:51], v8, s[8:11], s36 offen sc1
    buffer_load_dwordx4 a[52:55], v9, s[8:11], s36 offen sc1
    buffer_load_dwordx4 a[56:59], v10, s[8:11], s36 offen sc1
    buffer_load_dwordx4 a[60:63], v11, s[8:11], s36 offen sc1
    s_add_u32 s36, s36, 524288
    s_waitcnt vmcnt(15)
    v_mfma_f32_16x16x32_bf16 v[32:35], a[108:111], v[112:115], v[32:35]
    v_mfma_f32_16x16x32_bf16 v[36:39], a[112:115], v[112:115], v[36:39]
    v_mfma_f32_16x16x32_bf16 v[40:43], a[116:119], v[112:115], v[40:43]
    v_mfma_f32_16x16x32_bf16 v[44:47], a[120:123], v[112:115], v[44:47]
    v_mfma_f32_16x16x32_bf16 v[48:51], a[124:127], v[112:115], v[48:51]
    s_waitcnt vmcnt(14)
    v_mfma_f32_16x16x32_bf16 v[52:55], a[108:111], v[116:119], v[52:55]
    v_mfma_f32_16x16x32_bf16 v[56:59], a[112:115], v[116:119], v[56:59]
    v_mfma_f32_16x16x32_bf16 v[60:63], a[116:119], v[116:119], v[60:63]
    v_mfma_f32_16x16x32_bf16 v[64:67], a[120:123], v[116:119], v[64:67]
    v_mfma_f32_16x16x32_bf16 v[68:71], a[124:127], v[116:119], v[68:71]
    s_waitcnt vmcnt(13)
    v_mfma_f32_16x16x32_bf16 v[72:75], a[108:111], v[120:123], v[72:75]
    v_mfma_f32_16x16x32_bf16 v[76:79], a[112:115], v[120:123], v[76:79]
    v_mfma_f32_16x16x32_bf16 v[80:83], a[116:119], v[120:123], v[80:83]
    v_mfma_f32_16x16x32_bf16 v[84:87], a[120:123], v[120:123], v[84:87]
    v_mfma_f32_16x16x32_bf16 v[88:91], a[124:127], v[120:123], v[88:91]
    s_waitcnt vmcnt(12)
    v_mfma_f32_16x16x32_bf16 v[92:95], a[108:111], v[124:127], v[92:95]
    v_mfma_f32_16x16x32_bf16 v[96:99], a[112:115], v[124:127], v[96:99]
    v_mfma_f32_16x16x32_bf16 v[100:103], a[116:119], v[124:127], v[100:103]
    v_mfma_f32_16x16x32_bf16 v[104:107], a[120:123], v[124:127], v[104:107]
    v_mfma_f32_16x16x32_bf16 v[108:111], a[124:127], v[124:127], v[108:111]
    ds_read_b128 a[108:111], v2 offset:0
    ds_read_b128 a[112:115], v2 offset:1024
    ds_read_b128 a[116:119], v2 offset:2048
    ds_read_b128 a[120:123], v2 offset:3072
    ds_read_b128 a[124:127], v2 offset:4096
    buffer_load_dwordx4 v[112:115], v8, s[8:11], s36 offen sc1
    buffer_load_dwordx4 v[116:119], v9, s[8:11], s36 offen sc1
    buffer_load_dwordx4 v[120:123], v10, s[8:11], s36 offen sc1
    buffer_load_dwordx4 v[124:127], v11, s[8:11], s36 offen sc1
    s_add_u32 s36, s36, 524288
    s_waitcnt lgkmcnt(10)
    s_waitcnt vmcnt(15)
    v_mfma_f32_16x16x32_bf16 v[32:35], a[32:35], a[0:3], v[32:35]
    v_mfma_f32_16x16x32_bf16 v[36:39], a[36:39], a[0:3], v[36:39]
    v_mfma_f32_16x16x32_bf16 v[40:43], a[40:43], a[0:3], v[40:43]
    v_mfma_f32_16x16x32_bf16 v[44:47], a[44:47], a[0:3], v[44:47]
    v_mfma_f32_16x16x32_bf16 v[48:51], a[64:67], a[0:3], v[48:51]
    s_waitcnt vmcnt(14)
    v_mfma_f32_16x16x32_bf16 v[52:55], a[32:35], a[4:7], v[52:55]
    v_mfma_f32_16x16x32_bf16 v[56:59], a[36:39], a[4:7], v[56:59]
    v_mfma_f32_16x16x32_bf16 v[60:63], a[40:43], a[4:7], v[60:63]
    v_mfma_f32_16x16x32_bf16 v[64:67], a[44:47], a[4:7], v[64:67]
    v_mfma_f32_16x16x32_bf16 v[68:71], a[64:67], a[4:7], v[68:71]
    s_waitcnt vmcnt(13)
    v_mfma_f32_16x16x32_bf16 v[72:75], a[32:35], a[8:11], v[72:75]
    v_mfma_f32_16x16x32_bf16 v[76:79], a[36:39], a[8:11], v[76:79]
    v_mfma_f32_16x16x32_bf16 v[80:83], a[40:43], a[8:11], v[80:83]
    v_mfma_f32_16x16x32_bf16 v[84:87], a[44:47], a[8:11], v[84:87]
    v_mfma_f32_16x16x32_bf16 v[88:91], a[64:67], a[8:11], v[88:91]
    s_waitcnt vmcnt(12)
    v_mfma_f32_16x16x32_bf16 v[92:95], a[32:35], a[12:15], v[92:95]
    v_mfma_f32_16x16x32_bf16 v[96:99], a[36:39], a[12:15], v[96:99]
    v_mfma_f32_16x16x32_bf16 v[100:103], a[40:43], a[12:15], v[100:103]
    v_mfma_f32_16x16x32_bf16 v[104:107], a[44:47], a[12:15], v[104:107]
    v_mfma_f32_16x16x32_bf16 v[108:111], a[64:67], a[12:15], v[108:111]
    ds_read_b128 a[32:35], v2 offset:5120
    ds_read_b128 a[36:39], v2 offset:6144
    ds_read_b128 a[40:43], v2 offset:7168
    ds_read_b128 a[44:47], v2 offset:8192
    ds_read_b128 a[64:67], v2 offset:9216
    buffer_load_dwordx4 a[0:3], v8, s[8:11], s36 offen sc1
    buffer_load_dwordx4 a[4:7], v9, s[8:11], s36 offen sc1
    buffer_load_dwordx4 a[8:11], v10, s[8:11], s36 offen sc1
    buffer_load_dwordx4 a[12:15], v11, s[8:11], s36 offen sc1
    s_add_u32 s36, s36, 524288
    s_waitcnt lgkmcnt(10)
    s_waitcnt vmcnt(15)
    v_mfma_f32_16x16x32_bf16 v[32:35], a[68:71], a[16:19], v[32:35]
    v_mfma_f32_16x16x32_bf16 v[36:39], a[72:75], a[16:19], v[36:39]
    v_mfma_f32_16x16x32_bf16 v[40:43], a[76:79], a[16:19], v[40:43]
    v_mfma_f32_16x16x32_bf16 v[44:47], a[80:83], a[16:19], v[44:47]
    v_mfma_f32_16x16x32_bf16 v[48:51], a[84:87], a[16:19], v[48:51]
    s_waitcnt vmcnt(14)
    v_mfma_f32_16x16x32_bf16 v[52:55], a[68:71], a[20:23], v[52:55]
    v_mfma_f32_16x16x32_bf16 v[56:59], a[72:75], a[20:23], v[56:59]
    v_mfma_f32_16x16x32_bf16 v[60:63], a[76:79], a[20:23], v[60:63]
    v_mfma_f32_16x16x32_bf16 v[64:67], a[80:83], a[20:23], v[64:67]
    v_mfma_f32_16x16x32_bf16 v[68:71], a[84:87], a[20:23], v[68:71]
    s_waitcnt vmcnt(13)
    v_mfma_f32_16x16x32_bf16 v[72:75], a[68:71], a[24:27], v[72:75]
    v_mfma_f32_16x16x32_bf16 v[76:79], a[72:75], a[24:27], v[76:79]
    v_mfma_f32_16x16x32_bf16 v[80:83], a[76:79], a[24:27], v[80:83]
    v_mfma_f32_16x16x32_bf16 v[84:87], a[80:83], a[24:27], v[84:87]
    v_mfma_f32_16x16x32_bf16 v[88:91], a[84:87], a[24:27], v[88:91]
    s_waitcnt vmcnt(12)
    v_mfma_f32_16x16x32_bf16 v[92:95], a[68:71], a[28:31], v[92:95]
    v_mfma_f32_16x16x32_bf16 v[96:99], a[72:75], a[28:31], v[96:99]
    v_mfma_f32_16x16x32_bf16 v[100:103], a[76:79], a[28:31], v[100:103]
    v_mfma_f32_16x16x32_bf16 v[104:107], a[80:83], a[28:31], v[104:107]
    v_mfma_f32_16x16x32_bf16 v[108:111], a[84:87], a[28:31], v[108:111]
    ds_read_b128 a[68:71], v2 offset:10240
    ds_read_b128 a[72:75], v2 offset:11264
    ds_read_b128 a[76:79], v2 offset:12288
    ds_read_b128 a[80:83], v2 offset:13312
    ds_read_b128 a[84:87], v2 offset:14336
    buffer_load_dwordx4 a[16:19], v8, s[8:11], s36 offen sc1
    buffer_load_dwordx4 a[20:23], v9, s[8:11], s36 offen sc1
    buffer_load_dwordx4 a[24:27], v10, s[8:11], s36 offen sc1
    buffer_load_dwordx4 a[28:31], v11, s[8:11], s36 offen sc1
    s_add_u32 s36, s36, 524288
    s_waitcnt lgkmcnt(10)
    s_waitcnt vmcnt(15)
    v_mfma_f32_16x16x32_bf16 v[32:35], a[88:91], a[48:51], v[32:35]
    v_mfma_f32_16x16x32_bf16 v[36:39], a[92:95], a[48:51], v[36:39]
    v_mfma_f32_16x16x32_bf16 v[40:43], a[96:99], a[48:51], v[40:43]
    v_mfma_f32_16x16x32_bf16 v[44:47], a[100:103], a[48:51], v[44:47]
    v_mfma_f32_16x16x32_bf16 v[48:51], a[104:107], a[48:51], v[48:51]
    s_waitcnt vmcnt(14)
    v_mfma_f32_16x16x32_bf16 v[52:55], a[88:91], a[52:55], v[52:55]
    v_mfma_f32_16x16x32_bf16 v[56:59], a[92:95], a[52:55], v[56:59]
    v_mfma_f32_16x16x32_bf16 v[60:63], a[96:99], a[52:55], v[60:63]
    v_mfma_f32_16x16x32_bf16 v[64:67], a[100:103], a[52:55], v[64:67]
    v_mfma_f32_16x16x32_bf16 v[68:71], a[104:107], a[52:55], v[68:71]
    s_waitcnt vmcnt(13)
    v_mfma_f32_16x16x32_bf16 v[72:75], a[88:91], a[56:59], v[72:75]
    v_mfma_f32_16x16x32_bf16 v[76:79], a[92:95], a[56:59], v[76:79]
    v_mfma_f32_16x16x32_bf16 v[80:83], a[96:99], a[56:59], v[80:83]
    v_mfma_f32_16x16x32_bf16 v[84:87], a[100:103], a[56:59], v[84:87]
    v_mfma_f32_16x16x32_bf16 v[88:91], a[104:107], a[56:59], v[88:91]
    s_waitcnt vmcnt(12)
    v_mfma_f32_16x16x32_bf16 v[92:95], a[88:91], a[60:63], v[92:95]
    v_mfma_f32_16x16x32_bf16 v[96:99], a[92:95], a[60:63], v[96:99]
    v_mfma_f32_16x16x32_bf16 v[100:103], a[96:99], a[60:63], v[100:103]
    v_mfma_f32_16x16x32_bf16 v[104:107], a[100:103], a[60:63], v[104:107]
    v_mfma_f32_16x16x32_bf16 v[108:111], a[104:107], a[60:63], v[108:111]
    ds_read_b128 a[88:91], v2 offset:15360
    ds_read_b128 a[92:95], v2 offset:16384
    ds_read_b128 a[96:99], v2 offset:17408
    ds_read_b128 a[100:103], v2 offset:18432
    ds_read_b128 a[104:107], v2 offset:19456
    buffer_load_dwordx4 a[48:51], v8, s[8:11], s36 offen sc1
    buffer_load_dwordx4 a[52:55], v9, s[8:11], s36 offen sc1
    buffer_load_dwordx4 a[56:59], v10, s[8:11], s36 offen sc1
    buffer_load_dwordx4 a[60:63], v11, s[8:11], s36 offen sc1
    s_add_u32 s36, s36, 524288
    s_waitcnt lgkmcnt(10)
    s_waitcnt vmcnt(15)
    v_mfma_f32_16x16x32_bf16 v[32:35], a[108:111], v[112:115], v[32:35]
    v_mfma_f32_16x16x32_bf16 v[36:39], a[112:115], v[112:115], v[36:39]
    v_mfma_f32_16x16x32_bf16 v[40:43], a[116:119], v[112:115], v[40:43]
    v_mfma_f32_16x16x32_bf16 v[44:47], a[120:123], v[112:115], v[44:47]
    v_mfma_f32_16x16x32_bf16 v[48:51], a[124:127], v[112:115], v[48:51]
    s_waitcnt vmcnt(14)
    v_mfma_f32_16x16x32_bf16 v[52:55], a[108:111], v[116:119], v[52:55]
    v_mfma_f32_16x16x32_bf16 v[56:59], a[112:115], v[116:119], v[56:59]
    v_mfma_f32_16x16x32_bf16 v[60:63], a[116:119], v[116:119], v[60:63]
    v_mfma_f32_16x16x32_bf16 v[64:67], a[120:123], v[116:119], v[64:67]
    v_mfma_f32_16x16x32_bf16 v[68:71], a[124:127], v[116:119], v[68:71]
    s_waitcnt vmcnt(13)
    v_mfma_f32_16x16x32_bf16 v[72:75], a[108:111], v[120:123], v[72:75]
    v_mfma_f32_16x16x32_bf16 v[76:79], a[112:115], v[120:123], v[76:79]
    v_mfma_f32_16x16x32_bf16 v[80:83], a[116:119], v[120:123], v[80:83]
    v_mfma_f32_16x16x32_bf16 v[84:87], a[120:123], v[120:123], v[84:87]
    v_mfma_f32_16x16x32_bf16 v[88:91], a[124:127], v[120:123], v[88:91]
    s_waitcnt vmcnt(12)
    v_mfma_f32_16x16x32_bf16 v[92:95], a[108:111], v[124:127], v[92:95]
    v_mfma_f32_16x16x32_bf16 v[96:99], a[112:115], v[124:127], v[96:99]
    v_mfma_f32_16x16x32_bf16 v[100:103], a[116:119], v[124:127], v[100:103]
    v_mfma_f32_16x16x32_bf16 v[104:107], a[120:123], v[124:127], v[104:107]
    v_mfma_f32_16x16x32_bf16 v[108:111], a[124:127], v[124:127], v[108:111]
    s_add_u32 s56, s52, 225280
    buffer_load_dwordx4 a[108:111], v3, s[48:51], s56 offen offset:0
    buffer_load_dwordx4 a[112:115], v3, s[48:51], s56 offen offset:1024
    buffer_load_dwordx4 a[116:119], v3, s[48:51], s56 offen offset:2048
    buffer_load_dwordx4 a[120:123], v3, s[48:51], s56 offen offset:3072
    s_add_u32 s56, s52, 229376
    buffer_load_dwordx4 a[124:127], v3, s[48:51], s56 offen offset:0
    buffer_load_dwordx4 v[112:115], v8, s[8:11], s36 offen sc1
    buffer_load_dwordx4 v[116:119], v9, s[8:11], s36 offen sc1
    buffer_load_dwordx4 v[120:123], v10, s[8:11], s36 offen sc1
    buffer_load_dwordx4 v[124:127], v11, s[8:11], s36 offen sc1
    s_add_u32 s36, s36, 524288
    s_waitcnt lgkmcnt(10)
    s_waitcnt vmcnt(20)
    v_mfma_f32_16x16x32_bf16 v[32:35], a[32:35], a[0:3], v[32:35]
    v_mfma_f32_16x16x32_bf16 v[36:39], a[36:39], a[0:3], v[36:39]
    v_mfma_f32_16x16x32_bf16 v[40:43], a[40:43], a[0:3], v[40:43]
    v_mfma_f32_16x16x32_bf16 v[44:47], a[44:47], a[0:3], v[44:47]
    v_mfma_f32_16x16x32_bf16 v[48:51], a[64:67], a[0:3], v[48:51]
    s_waitcnt vmcnt(19)
    v_mfma_f32_16x16x32_bf16 v[52:55], a[32:35], a[4:7], v[52:55]
    v_mfma_f32_16x16x32_bf16 v[56:59], a[36:39], a[4:7], v[56:59]
    v_mfma_f32_16x16x32_bf16 v[60:63], a[40:43], a[4:7], v[60:63]
    v_mfma_f32_16x16x32_bf16 v[64:67], a[44:47], a[4:7], v[64:67]
    v_mfma_f32_16x16x32_bf16 v[68:71], a[64:67], a[4:7], v[68:71]
    s_waitcnt vmcnt(18)
    v_mfma_f32_16x16x32_bf16 v[72:75], a[32:35], a[8:11], v[72:75]
    v_mfma_f32_16x16x32_bf16 v[76:79], a[36:39], a[8:11], v[76:79]
    v_mfma_f32_16x16x32_bf16 v[80:83], a[40:43], a[8:11], v[80:83]
    v_mfma_f32_16x16x32_bf16 v[84:87], a[44:47], a[8:11], v[84:87]
    v_mfma_f32_16x16x32_bf16 v[88:91], a[64:67], a[8:11], v[88:91]
    s_waitcnt vmcnt(17)
    v_mfma_f32_16x16x32_bf16 v[92:95], a[32:35], a[12:15], v[92:95]
    v_mfma_f32_16x16x32_bf16 v[96:99], a[36:39], a[12:15], v[96:99]
    v_mfma_f32_16x16x32_bf16 v[100:103], a[40:43], a[12:15], v[100:103]
    v_mfma_f32_16x16x32_bf16 v[104:107], a[44:47], a[12:15], v[104:107]
    v_mfma_f32_16x16x32_bf16 v[108:111], a[64:67], a[12:15], v[108:111]
    s_add_u32 s56, s52, 245760
    buffer_load_dwordx4 a[32:35], v3, s[48:51], s56 offen offset:0
    buffer_load_dwordx4 a[36:39], v3, s[48:51], s56 offen offset:1024
    buffer_load_dwordx4 a[40:43], v3, s[48:51], s56 offen offset:2048
    buffer_load_dwordx4 a[44:47], v3, s[48:51], s56 offen offset:3072
    s_add_u32 s56, s52, 249856
    buffer_load_dwordx4 a[64:67], v3, s[48:51], s56 offen offset:0
    buffer_load_dwordx4 a[0:3], v8, s[8:11], s36 offen sc1
    buffer_load_dwordx4 a[4:7], v9, s[8:11], s36 offen sc1
    buffer_load_dwordx4 a[8:11], v10, s[8:11], s36 offen sc1
    buffer_load_dwordx4 a[12:15], v11, s[8:11], s36 offen sc1
    s_add_u32 s36, s36, 524288
    s_waitcnt lgkmcnt(5)
    s_waitcnt vmcnt(25)
    v_mfma_f32_16x16x32_bf16 v[32:35], a[68:71], a[16:19], v[32:35]
    v_mfma_f32_16x16x32_bf16 v[36:39], a[72:75], a[16:19], v[36:39]
    v_mfma_f32_16x16x32_bf16 v[40:43], a[76:79], a[16:19], v[40:43]
    v_mfma_f32_16x16x32_bf16 v[44:47], a[80:83], a[16:19], v[44:47]
    v_mfma_f32_16x16x32_bf16 v[48:51], a[84:87], a[16:19], v[48:51]
    s_waitcnt vmcnt(24)
    v_mfma_f32_16x16x32_bf16 v[52:55], a[68:71], a[20:23], v[52:55]
    v_mfma_f32_16x16x32_bf16 v[56:59], a[72:75], a[20:23], v[56:59]
    v_mfma_f32_16x16x32_bf16 v[60:63], a[76:79], a[20:23], v[60:63]
    v_mfma_f32_16x16x32_bf16 v[64:67], a[80:83], a[20:23], v[64:67]
    v_mfma_f32_16x16x32_bf16 v[68:71], a[84:87], a[20:23], v[68:71]
    s_waitcnt vmcnt(23)
    v_mfma_f32_16x16x32_bf16 v[72:75], a[68:71], a[24:27], v[72:75]
    v_mfma_f32_16x16x32_bf16 v[76:79], a[72:75], a[24:27], v[76:79]
    v_mfma_f32_16x16x32_bf16 v[80:83], a[76:79], a[24:27], v[80:83]
    v_mfma_f32_16x16x32_bf16 v[84:87], a[80:83], a[24:27], v[84:87]
    v_mfma_f32_16x16x32_bf16 v[88:91], a[84:87], a[24:27], v[88:91]
    s_waitcnt vmcnt(22)
    v_mfma_f32_16x16x32_bf16 v[92:95], a[68:71], a[28:31], v[92:95]
    v_mfma_f32_16x16x32_bf16 v[96:99], a[72:75], a[28:31], v[96:99]
    v_mfma_f32_16x16x32_bf16 v[100:103], a[76:79], a[28:31], v[100:103]
    v_mfma_f32_16x16x32_bf16 v[104:107], a[80:83], a[28:31], v[104:107]
    v_mfma_f32_16x16x32_bf16 v[108:111], a[84:87], a[28:31], v[108:111]
    s_add_u32 s56, s52, 266240
    buffer_load_dwordx4 a[68:71], v3, s[48:51], s56 offen offset:0
    buffer_load_dwordx4 a[72:75], v3, s[48:51], s56 offen offset:1024
    buffer_load_dwordx4 a[76:79], v3, s[48:51], s56 offen offset:2048
    buffer_load_dwordx4 a[80:83], v3, s[48:51], s56 offen offset:3072
    s_add_u32 s56, s52, 270336
    buffer_load_dwordx4 a[84:87], v3, s[48:51], s56 offen offset:0
    buffer_load_dwordx4 a[16:19], v8, s[8:11], s36 offen sc1
    buffer_load_dwordx4 a[20:23], v9, s[8:11], s36 offen sc1
    buffer_load_dwordx4 a[24:27], v10, s[8:11], s36 offen sc1
    buffer_load_dwordx4 a[28:31], v11, s[8:11], s36 offen sc1
    s_add_u32 s36, s36, 524288
    s_waitcnt lgkmcnt(0)
    s_waitcnt vmcnt(30)
    v_mfma_f32_16x16x32_bf16 v[32:35], a[88:91], a[48:51], v[32:35]
    v_mfma_f32_16x16x32_bf16 v[36:39], a[92:95], a[48:51], v[36:39]
    v_mfma_f32_16x16x32_bf16 v[40:43], a[96:99], a[48:51], v[40:43]
    v_mfma_f32_16x16x32_bf16 v[44:47], a[100:103], a[48:51], v[44:47]
    v_mfma_f32_16x16x32_bf16 v[48:51], a[104:107], a[48:51], v[48:51]
    s_waitcnt vmcnt(29)
    v_mfma_f32_16x16x32_bf16 v[52:55], a[88:91], a[52:55], v[52:55]
    v_mfma_f32_16x16x32_bf16 v[56:59], a[92:95], a[52:55], v[56:59]
    v_mfma_f32_16x16x32_bf16 v[60:63], a[96:99], a[52:55], v[60:63]
    v_mfma_f32_16x16x32_bf16 v[64:67], a[100:103], a[52:55], v[64:67]
    v_mfma_f32_16x16x32_bf16 v[68:71], a[104:107], a[52:55], v[68:71]
    s_waitcnt vmcnt(28)
    v_mfma_f32_16x16x32_bf16 v[72:75], a[88:91], a[56:59], v[72:75]
    v_mfma_f32_16x16x32_bf16 v[76:79], a[92:95], a[56:59], v[76:79]
    v_mfma_f32_16x16x32_bf16 v[80:83], a[96:99], a[56:59], v[80:83]
    v_mfma_f32_16x16x32_bf16 v[84:87], a[100:103], a[56:59], v[84:87]
    v_mfma_f32_16x16x32_bf16 v[88:91], a[104:107], a[56:59], v[88:91]
    s_waitcnt vmcnt(27)
    v_mfma_f32_16x16x32_bf16 v[92:95], a[88:91], a[60:63], v[92:95]
    v_mfma_f32_16x16x32_bf16 v[96:99], a[92:95], a[60:63], v[96:99]
    v_mfma_f32_16x16x32_bf16 v[100:103], a[96:99], a[60:63], v[100:103]
    v_mfma_f32_16x16x32_bf16 v[104:107], a[100:103], a[60:63], v[104:107]
    v_mfma_f32_16x16x32_bf16 v[108:111], a[104:107], a[60:63], v[108:111]
    s_waitcnt vmcnt(21)
    v_mfma_f32_16x16x32_bf16 v[32:35], a[108:111], v[112:115], v[32:35]
    v_mfma_f32_16x16x32_bf16 v[36:39], a[112:115], v[112:115], v[36:39]
    v_mfma_f32_16x16x32_bf16 v[40:43], a[116:119], v[112:115], v[40:43]
    v_mfma_f32_16x16x32_bf16 v[44:47], a[120:123], v[112:115], v[44:47]
    v_mfma_f32_16x16x32_bf16 v[48:51], a[124:127], v[112:115], v[48:51]
    s_waitcnt vmcnt(20)
    v_mfma_f32_16x16x32_bf16 v[52:55], a[108:111], v[116:119], v[52:55]
    v_mfma_f32_16x16x32_bf16 v[56:59], a[112:115], v[116:119], v[56:59]
    v_mfma_f32_16x16x32_bf16 v[60:63], a[116:119], v[116:119], v[60:63]
    v_mfma_f32_16x16x32_bf16 v[64:67], a[120:123], v[116:119], v[64:67]
    v_mfma_f32_16x16x32_bf16 v[68:71], a[124:127], v[116:119], v[68:71]
    s_waitcnt vmcnt(19)
    v_mfma_f32_16x16x32_bf16 v[72:75], a[108:111], v[120:123], v[72:75]
    v_mfma_f32_16x16x32_bf16 v[76:79], a[112:115], v[120:123], v[76:79]
    v_mfma_f32_16x16x32_bf16 v[80:83], a[116:119], v[120:123], v[80:83]
    v_mfma_f32_16x16x32_bf16 v[84:87], a[120:123], v[120:123], v[84:87]
    v_mfma_f32_16x16x32_bf16 v[88:91], a[124:127], v[120:123], v[88:91]
    s_waitcnt vmcnt(18)
    v_mfma_f32_16x16x32_bf16 v[92:95], a[108:111], v[124:127], v[92:95]
    v_mfma_f32_16x16x32_bf16 v[96:99], a[112:115], v[124:127], v[96:99]
    v_mfma_f32_16x16x32_bf16 v[100:103], a[116:119], v[124:127], v[100:103]
    v_mfma_f32_16x16x32_bf16 v[104:107], a[120:123], v[124:127], v[104:107]
    v_mfma_f32_16x16x32_bf16 v[108:111], a[124:127], v[124:127], v[108:111]
    s_waitcnt vmcnt(12)
    v_mfma_f32_16x16x32_bf16 v[32:35], a[32:35], a[0:3], v[32:35]
    v_mfma_f32_16x16x32_bf16 v[36:39], a[36:39], a[0:3], v[36:39]
    v_mfma_f32_16x16x32_bf16 v[40:43], a[40:43], a[0:3], v[40:43]
    v_mfma_f32_16x16x32_bf16 v[44:47], a[44:47], a[0:3], v[44:47]
    v_mfma_f32_16x16x32_bf16 v[48:51], a[64:67], a[0:3], v[48:51]
    s_waitcnt vmcnt(11)
    v_mfma_f32_16x16x32_bf16 v[52:55], a[32:35], a[4:7], v[52:55]
    v_mfma_f32_16x16x32_bf16 v[56:59], a[36:39], a[4:7], v[56:59]
    v_mfma_f32_16x16x32_bf16 v[60:63], a[40:43], a[4:7], v[60:63]
    v_mfma_f32_16x16x32_bf16 v[64:67], a[44:47], a[4:7], v[64:67]
    v_mfma_f32_16x16x32_bf16 v[68:71], a[64:67], a[4:7], v[68:71]
    s_waitcnt vmcnt(10)
    v_mfma_f32_16x16x32_bf16 v[72:75], a[32:35], a[8:11], v[72:75]
    v_mfma_f32_16x16x32_bf16 v[76:79], a[36:39], a[8:11], v[76:79]
    v_mfma_f32_16x16x32_bf16 v[80:83], a[40:43], a[8:11], v[80:83]
    v_mfma_f32_16x16x32_bf16 v[84:87], a[44:47], a[8:11], v[84:87]
    v_mfma_f32_16x16x32_bf16 v[88:91], a[64:67], a[8:11], v[88:91]
    s_waitcnt vmcnt(9)
    v_mfma_f32_16x16x32_bf16 v[92:95], a[32:35], a[12:15], v[92:95]
    v_mfma_f32_16x16x32_bf16 v[96:99], a[36:39], a[12:15], v[96:99]
    v_mfma_f32_16x16x32_bf16 v[100:103], a[40:43], a[12:15], v[100:103]
    v_mfma_f32_16x16x32_bf16 v[104:107], a[44:47], a[12:15], v[104:107]
    v_mfma_f32_16x16x32_bf16 v[108:111], a[64:67], a[12:15], v[108:111]
    s_waitcnt vmcnt(3)
    v_mfma_f32_16x16x32_bf16 v[32:35], a[68:71], a[16:19], v[32:35]
    v_mfma_f32_16x16x32_bf16 v[36:39], a[72:75], a[16:19], v[36:39]
    v_mfma_f32_16x16x32_bf16 v[40:43], a[76:79], a[16:19], v[40:43]
    v_mfma_f32_16x16x32_bf16 v[44:47], a[80:83], a[16:19], v[44:47]
    v_mfma_f32_16x16x32_bf16 v[48:51], a[84:87], a[16:19], v[48:51]
    s_waitcnt vmcnt(2)
    v_mfma_f32_16x16x32_bf16 v[52:55], a[68:71], a[20:23], v[52:55]
    v_mfma_f32_16x16x32_bf16 v[56:59], a[72:75], a[20:23], v[56:59]
    v_mfma_f32_16x16x32_bf16 v[60:63], a[76:79], a[20:23], v[60:63]
    v_mfma_f32_16x16x32_bf16 v[64:67], a[80:83], a[20:23], v[64:67]
    v_mfma_f32_16x16x32_bf16 v[68:71], a[84:87], a[20:23], v[68:71]
    s_waitcnt vmcnt(1)
    v_mfma_f32_16x16x32_bf16 v[72:75], a[68:71], a[24:27], v[72:75]
    v_mfma_f32_16x16x32_bf16 v[76:79], a[72:75], a[24:27], v[76:79]
    v_mfma_f32_16x16x32_bf16 v[80:83], a[76:79], a[24:27], v[80:83]
    v_mfma_f32_16x16x32_bf16 v[84:87], a[80:83], a[24:27], v[84:87]
    v_mfma_f32_16x16x32_bf16 v[88:91], a[84:87], a[24:27], v[88:91]
    s_waitcnt vmcnt(0)
    v_mfma_f32_16x16x32_bf16 v[92:95], a[68:71], a[28:31], v[92:95]
    v_mfma_f32_16x16x32_bf16 v[96:99], a[72:75], a[28:31], v[96:99]
    v_mfma_f32_16x16x32_bf16 v[100:103], a[76:79], a[28:31], v[100:103]
    v_mfma_f32_16x16x32_bf16 v[104:107], a[80:83], a[28:31], v[104:107]
    v_mfma_f32_16x16x32_bf16 v[108:111], a[84:87], a[28:31], v[108:111]
    v_add_f32 v16, v16, v17
    s_nop 1
    v_cvt_pk_bf16_f32 v16, v16, v16
    v_lshlrev_b32 v16, 16, v16
    v_cmp_gt_u32 vcc, 80, v0
    s_and_saveexec_b64 s[6:7], vcc
    v_add_u32 v12, 81920, v12
    ds_write_b32 v12, v16
    s_mov_b64 exec, -1
    ds_write_b128 v4, v[52:55] offset:0
    ds_write_b128 v4, v[56:59] offset:1024
    ds_write_b128 v4, v[60:63] offset:2048
    ds_write_b128 v4, v[64:67] offset:3072
    ds_write_b128 v4, v[68:71] offset:4096
    ds_write_b128 v4, v[72:75] offset:20480
    ds_write_b128 v4, v[76:79] offset:21504
    ds_write_b128 v4, v[80:83] offset:22528
    ds_write_b128 v4, v[84:87] offset:23552
    ds_write_b128 v4, v[88:91] offset:24576
    ds_write_b128 v4, v[92:95] offset:40960
    ds_write_b128 v4, v[96:99] offset:41984
    ds_write_b128 v4, v[100:103] offset:43008
    ds_write_b128 v4, v[104:107] offset:44032
    ds_write_b128 v4, v[108:111] offset:45056
    v_mul_u32_u24 v15, 80, v6
    v_add_u32 v15, 81920, v15
    s_waitcnt lgkmcnt(0)
    s_barrier
    s_xor_b32 s7, s32, 1
    s_mul_i32 s7, s7, 5120
    s_add_u32 s7, s7, 83968
    v_add_u32 v14, s7, v3
    ds_read_b128 v[52:55], v14 offset:0
    ds_read_b128 v[56:59], v14 offset:1024
    ds_read_b128 v[60:63], v14 offset:2048
    ds_read_b128 v[64:67], v14 offset:3072
    ds_read_b128 v[68:71], v14 offset:4096
    s_xor_b32 s7, s32, 2
    s_mul_i32 s7, s7, 5120
    s_add_u32 s7, s7, 83968
    v_add_u32 v14, s7, v3
    ds_read_b128 v[72:75], v14 offset:20480
    ds_read_b128 v[76:79], v14 offset:21504
    ds_read_b128 v[80:83], v14 offset:22528
    ds_read_b128 v[84:87], v14 offset:23552
    ds_read_b128 v[88:91], v14 offset:24576
    s_waitcnt lgkmcnt(5)
    v_pk_add_f32 v[32:33], v[32:33], v[52:53]
    v_pk_add_f32 v[34:35], v[34:35], v[54:55]
    v_pk_add_f32 v[36:37], v[36:37], v[56:57]
    v_pk_add_f32 v[38:39], v[38:39], v[58:59]
    v_pk_add_f32 v[40:41], v[40:41], v[60:61]
    v_pk_add_f32 v[42:43], v[42:43], v[62:63]
    v_pk_add_f32 v[44:45], v[44:45], v[64:65]
    v_pk_add_f32 v[46:47], v[46:47], v[66:67]
    v_pk_add_f32 v[48:49], v[48:49], v[68:69]
    v_pk_add_f32 v[50:51], v[50:51], v[70:71]
    s_xor_b32 s7, s32, 3
    s_mul_i32 s7, s7, 5120
    s_add_u32 s7, s7, 83968
    v_add_u32 v14, s7, v3
    ds_read_b128 v[92:95], v14 offset:40960
    ds_read_b128 v[96:99], v14 offset:41984
    ds_read_b128 v[100:103], v14 offset:43008
    ds_read_b128 v[104:107], v14 offset:44032
    ds_read_b128 v[108:111], v14 offset:45056
    ds_read_b128 v[52:55], v15 offset:0
    ds_read_b128 v[56:59], v15 offset:16
    ds_read_b128 v[60:63], v15 offset:32
    ds_read_b128 v[64:67], v15 offset:48
    ds_read_b128 v[68:71], v15 offset:64
    s_waitcnt lgkmcnt(5)
    v_pk_add_f32 v[72:73], v[72:73], v[92:93]
    v_pk_add_f32 v[74:75], v[74:75], v[94:95]
    v_pk_add_f32 v[76:77], v[76:77], v[96:97]
    v_pk_add_f32 v[78:79], v[78:79], v[98:99]
    v_pk_add_f32 v[80:81], v[80:81], v[100:101]
    v_pk_add_f32 v[82:83], v[82:83], v[102:103]
    v_pk_add_f32 v[84:85], v[84:85], v[104:105]
    v_pk_add_f32 v[86:87], v[86:87], v[106:107]
    v_pk_add_f32 v[88:89], v[88:89], v[108:109]
    v_pk_add_f32 v[90:91], v[90:91], v[110:111]
    v_pk_add_f32 v[32:33], v[32:33], v[72:73]
    v_pk_add_f32 v[34:35], v[34:35], v[74:75]
    v_pk_add_f32 v[36:37], v[36:37], v[76:77]
    v_pk_add_f32 v[38:39], v[38:39], v[78:79]
    v_pk_add_f32 v[40:41], v[40:41], v[80:81]
    v_pk_add_f32 v[42:43], v[42:43], v[82:83]
    v_pk_add_f32 v[44:45], v[44:45], v[84:85]
    v_pk_add_f32 v[46:47], v[46:47], v[86:87]
    v_pk_add_f32 v[48:49], v[48:49], v[88:89]
    v_pk_add_f32 v[50:51], v[50:51], v[90:91]
    v_mul_u32_u24 v13, 1280, v5
    v_mul_u32_u24 v14, 40, v6
    v_add_u32 v13, v13, v14
    s_lshl_b32 s3, s33, 2
    s_add_u32 s3, s3, s32
    s_mul_i32 s3, s3, 20480
    s_mul_i32 s6, s34, 160
    s_add_u32 s3, s3, s6
    s_waitcnt lgkmcnt(0)
    v_lshlrev_b32 v16, 16, v20
    v_and_b32 v17, 0xffff0000, v20
    v_pk_fma_f32 v[16:17], v[32:33], v[52:53], v[16:17]
    v_cvt_pk_bf16_f32 v72, v16, v17
    v_lshlrev_b32 v16, 16, v21
    v_and_b32 v17, 0xffff0000, v21
    v_pk_fma_f32 v[16:17], v[34:35], v[54:55], v[16:17]
    v_cvt_pk_bf16_f32 v73, v16, v17
    v_lshlrev_b32 v16, 16, v22
    v_and_b32 v17, 0xffff0000, v22
    v_pk_fma_f32 v[16:17], v[36:37], v[56:57], v[16:17]
    v_cvt_pk_bf16_f32 v74, v16, v17
    v_lshlrev_b32 v16, 16, v23
    v_and_b32 v17, 0xffff0000, v23
    v_pk_fma_f32 v[16:17], v[38:39], v[58:59], v[16:17]
    v_cvt_pk_bf16_f32 v75, v16, v17
    v_lshlrev_b32 v16, 16, v24
    v_and_b32 v17, 0xffff0000, v24
    v_pk_fma_f32 v[16:17], v[40:41], v[60:61], v[16:17]
    v_cvt_pk_bf16_f32 v76, v16, v17
    v_lshlrev_b32 v16, 16, v25
    v_and_b32 v17, 0xffff0000, v25
    v_pk_fma_f32 v[16:17], v[42:43], v[62:63], v[16:17]
    v_cvt_pk_bf16_f32 v77, v16, v17
    v_lshlrev_b32 v16, 16, v26
    v_and_b32 v17, 0xffff0000, v26
    v_pk_fma_f32 v[16:17], v[44:45], v[64:65], v[16:17]
    v_cvt_pk_bf16_f32 v78, v16, v17
    v_lshlrev_b32 v16, 16, v27
    v_and_b32 v17, 0xffff0000, v27
    v_pk_fma_f32 v[16:17], v[46:47], v[66:67], v[16:17]
    v_cvt_pk_bf16_f32 v79, v16, v17
    v_lshlrev_b32 v16, 16, v28
    v_and_b32 v17, 0xffff0000, v28
    v_pk_fma_f32 v[16:17], v[48:49], v[68:69], v[16:17]
    v_cvt_pk_bf16_f32 v80, v16, v17
    v_lshlrev_b32 v16, 16, v29
    v_and_b32 v17, 0xffff0000, v29
    v_pk_fma_f32 v[16:17], v[50:51], v[70:71], v[16:17]
    v_cvt_pk_bf16_f32 v81, v16, v17
    buffer_store_dwordx4 v[72:75], v13, s[24:27], s3 offen
    buffer_store_dwordx4 v[76:79], v13, s[24:27], s3 offen offset:16
    buffer_store_dwordx2 v[80:81], v13, s[24:27], s3 offen offset:32
    s_endpgm
k4_wm:
    s_add_u32 s8, s4, 18874368
    s_addc_u32 s9, s5, 0
    s_mov_b32 s10, 7077888
    s_mov_b32 s11, 0x00020000
    s_barrier
    s_waitcnt vmcnt(0)
k3_end:
    s_endpgm
k3_st:
    s_getpc_b64 s[8:9]
k3_pcr:
    s_sub_u32 s8, s8, k3_pcr-gemm1_kernel
    s_subb_u32 s9, s9, 0
    v_lshlrev_b32 v3, 4, v0
    s_mov_b32 s10, code_end-gemm1_kernel-16
    s_movk_i32 s11, 3
k3_pcr_l:
    v_min_u32 v6, s10, v3
    v_mov_b32 v5, s9
    v_add_co_u32 v4, vcc, s8, v6
    v_addc_co_u32 v5, vcc, 0, v5, vcc
    global_load_dwordx4 v[60:63], v[4:5], off
    v_add_u32 v3, 8192, v3
    s_sub_u32 s11, s11, 1
    s_cmp_lg_u32 s11, 0
    s_cbranch_scc1 k3_pcr_l
    v_and_b32 v3, 31, v0
    v_lshrrev_b32 v4, 5, v0
    v_lshlrev_b32 v4, 14, v4
    v_lshl_add_u32 v3, v3, 4, v4
    s_lshl_b32 s3, s2, 9
    s_mov_b32 s6, s3
    v_lshrrev_b32 v2, 6, v0
    s_waitcnt lgkmcnt(0)
    s_add_u32 s8, s4, 1048576
    s_addc_u32 s9, s5, 0
    s_mov_b32 s10, 2621440
    s_mov_b32 s11, 0x00020000
    s_add_u32 s24, s4, 98304
    s_addc_u32 s25, s5, 0
    s_mov_b32 s26, 16384
    s_mov_b32 s27, 0x00020000
    s_mov_b32 s30, 256
    s_mov_b32 s31, 0x00020000
    buffer_load_dwordx4 v[16:19], v3, s[8:11], s6 offen
    s_add_u32 s6, s6, 262144
    buffer_load_dwordx4 v[20:23], v3, s[8:11], s6 offen
    s_add_u32 s6, s6, 262144
    buffer_load_dwordx4 v[24:27], v3, s[8:11], s6 offen
    s_add_u32 s6, s6, 262144
    buffer_load_dwordx4 v[28:31], v3, s[8:11], s6 offen
    s_add_u32 s6, s6, 262144
    buffer_load_dwordx4 v[32:35], v3, s[8:11], s6 offen
    s_add_u32 s6, s6, 262144
    buffer_load_dwordx4 v[36:39], v3, s[8:11], s6 offen
    s_add_u32 s6, s6, 262144
    buffer_load_dwordx4 v[40:43], v3, s[8:11], s6 offen
    s_add_u32 s6, s6, 262144
    buffer_load_dwordx4 v[44:47], v3, s[8:11], s6 offen
    s_add_u32 s6, s6, 262144
    buffer_load_dwordx4 v[48:51], v3, s[8:11], s6 offen
    s_add_u32 s6, s6, 262144
    buffer_load_dwordx4 v[52:55], v3, s[8:11], s6 offen
    s_add_u32 s6, s6, 262144
    v_mov_b32 v8, 0
    v_mov_b32 v9, 0
    v_mov_b32 v10, 0
    v_mov_b32 v11, 0
    v_mov_b32 v12, 0x3f803f80
    v_readfirstlane_b32 s32, v2
    s_waitcnt vmcnt(9)
    v_dot2c_f32_bf16 v8, v12, v16
    v_dot2c_f32_bf16 v9, v16, v16
    v_dot2c_f32_bf16 v8, v12, v17
    v_dot2c_f32_bf16 v9, v17, v17
    v_dot2c_f32_bf16 v10, v12, v18
    v_dot2c_f32_bf16 v11, v18, v18
    v_dot2c_f32_bf16 v10, v12, v19
    v_dot2c_f32_bf16 v11, v19, v19
    s_waitcnt vmcnt(8)
    v_dot2c_f32_bf16 v8, v12, v20
    v_dot2c_f32_bf16 v9, v20, v20
    v_dot2c_f32_bf16 v8, v12, v21
    v_dot2c_f32_bf16 v9, v21, v21
    v_dot2c_f32_bf16 v10, v12, v22
    v_dot2c_f32_bf16 v11, v22, v22
    v_dot2c_f32_bf16 v10, v12, v23
    v_dot2c_f32_bf16 v11, v23, v23
    s_waitcnt vmcnt(7)
    v_dot2c_f32_bf16 v8, v12, v24
    v_dot2c_f32_bf16 v9, v24, v24
    v_dot2c_f32_bf16 v8, v12, v25
    v_dot2c_f32_bf16 v9, v25, v25
    v_dot2c_f32_bf16 v10, v12, v26
    v_dot2c_f32_bf16 v11, v26, v26
    v_dot2c_f32_bf16 v10, v12, v27
    v_dot2c_f32_bf16 v11, v27, v27
    s_waitcnt vmcnt(6)
    v_dot2c_f32_bf16 v8, v12, v28
    v_dot2c_f32_bf16 v9, v28, v28
    v_dot2c_f32_bf16 v8, v12, v29
    v_dot2c_f32_bf16 v9, v29, v29
    v_dot2c_f32_bf16 v10, v12, v30
    v_dot2c_f32_bf16 v11, v30, v30
    v_dot2c_f32_bf16 v10, v12, v31
    v_dot2c_f32_bf16 v11, v31, v31
    s_waitcnt vmcnt(5)
    v_dot2c_f32_bf16 v8, v12, v32
    v_dot2c_f32_bf16 v9, v32, v32
    v_dot2c_f32_bf16 v8, v12, v33
    v_dot2c_f32_bf16 v9, v33, v33
    v_dot2c_f32_bf16 v10, v12, v34
    v_dot2c_f32_bf16 v11, v34, v34
    v_dot2c_f32_bf16 v10, v12, v35
    v_dot2c_f32_bf16 v11, v35, v35
    s_waitcnt vmcnt(4)
    v_dot2c_f32_bf16 v8, v12, v36
    v_dot2c_f32_bf16 v9, v36, v36
    v_dot2c_f32_bf16 v8, v12, v37
    v_dot2c_f32_bf16 v9, v37, v37
    v_dot2c_f32_bf16 v10, v12, v38
    v_dot2c_f32_bf16 v11, v38, v38
    v_dot2c_f32_bf16 v10, v12, v39
    v_dot2c_f32_bf16 v11, v39, v39
    s_waitcnt vmcnt(3)
    v_dot2c_f32_bf16 v8, v12, v40
    v_dot2c_f32_bf16 v9, v40, v40
    v_dot2c_f32_bf16 v8, v12, v41
    v_dot2c_f32_bf16 v9, v41, v41
    v_dot2c_f32_bf16 v10, v12, v42
    v_dot2c_f32_bf16 v11, v42, v42
    v_dot2c_f32_bf16 v10, v12, v43
    v_dot2c_f32_bf16 v11, v43, v43
    s_waitcnt vmcnt(2)
    v_dot2c_f32_bf16 v8, v12, v44
    v_dot2c_f32_bf16 v9, v44, v44
    v_dot2c_f32_bf16 v8, v12, v45
    v_dot2c_f32_bf16 v9, v45, v45
    v_dot2c_f32_bf16 v10, v12, v46
    v_dot2c_f32_bf16 v11, v46, v46
    v_dot2c_f32_bf16 v10, v12, v47
    v_dot2c_f32_bf16 v11, v47, v47
    s_waitcnt vmcnt(1)
    v_dot2c_f32_bf16 v8, v12, v48
    v_dot2c_f32_bf16 v9, v48, v48
    v_dot2c_f32_bf16 v8, v12, v49
    v_dot2c_f32_bf16 v9, v49, v49
    v_dot2c_f32_bf16 v10, v12, v50
    v_dot2c_f32_bf16 v11, v50, v50
    v_dot2c_f32_bf16 v10, v12, v51
    v_dot2c_f32_bf16 v11, v51, v51
    s_waitcnt vmcnt(0)
    v_dot2c_f32_bf16 v8, v12, v52
    v_dot2c_f32_bf16 v9, v52, v52
    v_dot2c_f32_bf16 v8, v12, v53
    v_dot2c_f32_bf16 v9, v53, v53
    v_dot2c_f32_bf16 v10, v12, v54
    v_dot2c_f32_bf16 v11, v54, v54
    v_dot2c_f32_bf16 v10, v12, v55
    v_dot2c_f32_bf16 v11, v55, v55
    v_lshlrev_b32 v13, 4, v0
    s_nop 2
    ds_write_b128 v13, v[8:11]
    s_waitcnt lgkmcnt(0)
    s_barrier
    s_cmp_lg_u32 s32, 0
    s_cbranch_scc1 k3_s2
    v_lshlrev_b32 v13, 3, v0
    ds_read_b64 v[16:17], v13 offset:0
    ds_read_b64 v[18:19], v13 offset:512
    ds_read_b64 v[20:21], v13 offset:1024
    ds_read_b64 v[22:23], v13 offset:1536
    ds_read_b64 v[24:25], v13 offset:2048
    ds_read_b64 v[26:27], v13 offset:2560
    ds_read_b64 v[28:29], v13 offset:3072
    ds_read_b64 v[30:31], v13 offset:3584
    ds_read_b64 v[32:33], v13 offset:4096
    ds_read_b64 v[34:35], v13 offset:4608
    ds_read_b64 v[36:37], v13 offset:5120
    ds_read_b64 v[38:39], v13 offset:5632
    ds_read_b64 v[40:41], v13 offset:6144
    ds_read_b64 v[42:43], v13 offset:6656
    ds_read_b64 v[44:45], v13 offset:7168
    ds_read_b64 v[46:47], v13 offset:7680
    s_waitcnt lgkmcnt(0)
    v_pk_add_f32 v[16:17], v[16:17], v[32:33]
    v_pk_add_f32 v[18:19], v[18:19], v[34:35]
    v_pk_add_f32 v[20:21], v[20:21], v[36:37]
    v_pk_add_f32 v[22:23], v[22:23], v[38:39]
    v_pk_add_f32 v[24:25], v[24:25], v[40:41]
    v_pk_add_f32 v[26:27], v[26:27], v[42:43]
    v_pk_add_f32 v[28:29], v[28:29], v[44:45]
    v_pk_add_f32 v[30:31], v[30:31], v[46:47]
    v_pk_add_f32 v[16:17], v[16:17], v[24:25]
    v_pk_add_f32 v[18:19], v[18:19], v[26:27]
    v_pk_add_f32 v[20:21], v[20:21], v[28:29]
    v_pk_add_f32 v[22:23], v[22:23], v[30:31]
    v_pk_add_f32 v[16:17], v[16:17], v[20:21]
    v_pk_add_f32 v[18:19], v[18:19], v[22:23]
    v_pk_add_f32 v[16:17], v[16:17], v[18:19]
    v_mul_f32 v16, 0x3acccccd, v16
    v_mul_f32 v17, 0x3acccccd, v17
    v_fma_f32 v17, -v16, v16, v17
    v_max_f32 v17, 0, v17
    v_cvt_pk_bf16_f32 v16, v16, v16
    v_lshlrev_b32 v16, 16, v16
    v_cvt_pk_bf16_f32 v17, v17, v17
    v_lshlrev_b32 v17, 16, v17
    v_add_f32 v17, 0x3727c5ac, v17
    v_cvt_pk_bf16_f32 v17, v17, v17
    v_lshlrev_b32 v17, 16, v17
    v_sqrt_f32 v17, v17
    s_nop 0
    v_cvt_pk_bf16_f32 v17, v17, v17
    v_lshlrev_b32 v17, 16, v17
    v_rcp_f32 v17, v17
    s_nop 0
    v_mul_f32 v16, v16, v17
    v_sub_f32 v16, 0, v16
    buffer_store_dwordx2 v[16:17], v13, s[24:27], s3 offen sc1
    s_lshl_b32 s3, s2, 3
    s_waitcnt vmcnt(0)
    v_mov_b32 v8, 0
    v_mov_b32 v9, 1
    s_mov_b64 exec, 1
    buffer_store_dword v9, v8, s[28:31], s3 offen sc1
    s_mov_b64 exec, -1
k3_s2:
    v_and_b32 v3, 63, v0
    v_lshlrev_b32 v3, 4, v3
    s_and_b32 s3, s62, 7
    s_lshr_b32 s6, s62, 3
    s_lshl_b32 s3, s3, 2
    s_and_b32 s54, s6, 3
    s_add_u32 s54, s54, s3
    s_lshr_b32 s55, s6, 2
    s_and_b32 s3, s32, 3
    s_mul_i32 s52, s55, 54
    s_add_u32 s52, s52, s3
    s_mul_i32 s52, s52, 5120
    s_mul_i32 s53, s3, 5120
    s_and_b32 s6, s54, 3
    s_lshl_b32 s6, s6, 2
    s_add_u32 s6, s6, s3
    s_lshl_b32 s6, s6, 10
    s_mul_i32 s58, s55, 276480
    s_add_u32 s58, s58, s6
    s_lshl_b32 s6, s55, 2
    s_add_u32 s6, s6, s3
    s_lshl_b32 s6, s6, 15
    s_lshl_b32 s59, s54, 10
    s_add_u32 s59, s59, s6
    s_add_u32 s48, s4, 15728640
    s_addc_u32 s49, s5, 0
    s_mov_b32 s50, 2211840
    s_mov_b32 s51, 0x00020000
    s_lshr_b32 s3, s32, 2
    s_mul_i32 s6, s3, 10240
    s_lshl_b32 s7, s53, 2
    s_add_u32 s6, s6, s7
    s_mul_i32 s3, s3, 40960
    s_add_u32 s3, s3, s52
    s_barrier
    s_add_u32 m0, s6, 0
    s_add_u32 s56, s3, 143360
    buffer_load_dwordx4 v3, s[48:51], s56 offen lds
    s_add_u32 m0, s6, 1024
    s_add_u32 s56, s3, 144384
    buffer_load_dwordx4 v3, s[48:51], s56 offen lds
    s_add_u32 m0, s6, 2048
    s_add_u32 s56, s3, 145408
    buffer_load_dwordx4 v3, s[48:51], s56 offen lds
    s_add_u32 m0, s6, 3072
    s_add_u32 s56, s3, 146432
    buffer_load_dwordx4 v3, s[48:51], s56 offen lds
    s_add_u32 m0, s6, 4096
    s_add_u32 s56, s3, 147456
    buffer_load_dwordx4 v3, s[48:51], s56 offen lds
    s_add_u32 m0, s6, 5120
    s_add_u32 s56, s3, 163840
    buffer_load_dwordx4 v3, s[48:51], s56 offen lds
    s_add_u32 m0, s6, 6144
    s_add_u32 s56, s3, 164864
    buffer_load_dwordx4 v3, s[48:51], s56 offen lds
    s_add_u32 m0, s6, 7168
    s_add_u32 s56, s3, 165888
    buffer_load_dwordx4 v3, s[48:51], s56 offen lds
    s_add_u32 m0, s6, 8192
    s_add_u32 s56, s3, 166912
    buffer_load_dwordx4 v3, s[48:51], s56 offen lds
    s_add_u32 m0, s6, 9216
    s_add_u32 s56, s3, 167936
    buffer_load_dwordx4 v3, s[48:51], s56 offen lds
    s_cmp_ge_u32 s32, 4
    s_cbranch_scc1 k3_s3
    s_add_u32 s56, s52, 0
    buffer_load_dwordx4 a[32:35], v3, s[48:51], s56 offen offset:0
    buffer_load_dwordx4 a[36:39], v3, s[48:51], s56 offen offset:1024
    buffer_load_dwordx4 a[40:43], v3, s[48:51], s56 offen offset:2048
    buffer_load_dwordx4 a[44:47], v3, s[48:51], s56 offen offset:3072
    s_add_u32 s56, s52, 4096
    buffer_load_dwordx4 a[64:67], v3, s[48:51], s56 offen offset:0
    s_add_u32 s56, s52, 20480
    buffer_load_dwordx4 a[68:71], v3, s[48:51], s56 offen offset:0
    buffer_load_dwordx4 a[72:75], v3, s[48:51], s56 offen offset:1024
    buffer_load_dwordx4 a[76:79], v3, s[48:51], s56 offen offset:2048
    buffer_load_dwordx4 a[80:83], v3, s[48:51], s56 offen offset:3072
    s_add_u32 s56, s52, 24576
    buffer_load_dwordx4 a[84:87], v3, s[48:51], s56 offen offset:0
    s_add_u32 s56, s52, 40960
    buffer_load_dwordx4 a[88:91], v3, s[48:51], s56 offen offset:0
    buffer_load_dwordx4 a[92:95], v3, s[48:51], s56 offen offset:1024
    buffer_load_dwordx4 a[96:99], v3, s[48:51], s56 offen offset:2048
    buffer_load_dwordx4 a[100:103], v3, s[48:51], s56 offen offset:3072
    s_add_u32 s56, s52, 45056
    buffer_load_dwordx4 a[104:107], v3, s[48:51], s56 offen offset:0
    s_add_u32 s56, s52, 61440
    buffer_load_dwordx4 a[108:111], v3, s[48:51], s56 offen offset:0
    buffer_load_dwordx4 a[112:115], v3, s[48:51], s56 offen offset:1024
    buffer_load_dwordx4 a[116:119], v3, s[48:51], s56 offen offset:2048
    buffer_load_dwordx4 a[120:123], v3, s[48:51], s56 offen offset:3072
    s_add_u32 s56, s52, 65536
    buffer_load_dwordx4 a[124:127], v3, s[48:51], s56 offen offset:0
    s_branch k4_in
k3_s3:
    s_add_u32 m0, s53, 83968
    s_add_u32 s56, s52, 81920
    buffer_load_dwordx4 v3, s[48:51], s56 offen lds
    s_add_u32 m0, s53, 84992
    s_add_u32 s56, s52, 82944
    buffer_load_dwordx4 v3, s[48:51], s56 offen lds
    s_add_u32 m0, s53, 86016
    s_add_u32 s56, s52, 83968
    buffer_load_dwordx4 v3, s[48:51], s56 offen lds
    s_add_u32 m0, s53, 87040
    s_add_u32 s56, s52, 84992
    buffer_load_dwordx4 v3, s[48:51], s56 offen lds
    s_add_u32 m0, s53, 88064
    s_add_u32 s56, s52, 86016
    buffer_load_dwordx4 v3, s[48:51], s56 offen lds
    s_add_u32 m0, s53, 104448
    s_add_u32 s56, s52, 102400
    buffer_load_dwordx4 v3, s[48:51], s56 offen lds
    s_add_u32 m0, s53, 105472
    s_add_u32 s56, s52, 103424
    buffer_load_dwordx4 v3, s[48:51], s56 offen lds
    s_add_u32 m0, s53, 106496
    s_add_u32 s56, s52, 104448
    buffer_load_dwordx4 v3, s[48:51], s56 offen lds
    s_add_u32 m0, s53, 107520
    s_add_u32 s56, s52, 105472
    buffer_load_dwordx4 v3, s[48:51], s56 offen lds
    s_add_u32 m0, s53, 108544
    s_add_u32 s56, s52, 106496
    buffer_load_dwordx4 v3, s[48:51], s56 offen lds
    s_add_u32 m0, s53, 124928
    s_add_u32 s56, s52, 122880
    buffer_load_dwordx4 v3, s[48:51], s56 offen lds
    s_add_u32 m0, s53, 125952
    s_add_u32 s56, s52, 123904
    buffer_load_dwordx4 v3, s[48:51], s56 offen lds
    s_add_u32 m0, s53, 126976
    s_add_u32 s56, s52, 124928
    buffer_load_dwordx4 v3, s[48:51], s56 offen lds
    s_add_u32 m0, s53, 128000
    s_add_u32 s56, s52, 125952
    buffer_load_dwordx4 v3, s[48:51], s56 offen lds
    s_add_u32 m0, s53, 129024
    s_add_u32 s56, s52, 126976
    buffer_load_dwordx4 v3, s[48:51], s56 offen lds
    s_branch k4_in
code_end:
.section .rodata,"a"
.p2align 6
.amdhsa_kernel front_kernel
  .amdhsa_next_free_vgpr 256
  .amdhsa_next_free_sgpr 80
  .amdhsa_accum_offset 256
  .amdhsa_group_segment_fixed_size 0
  .amdhsa_kernarg_size 128
  .amdhsa_user_sgpr_count 2
  .amdhsa_user_sgpr_kernarg_segment_ptr 1
  .amdhsa_system_sgpr_workgroup_id_x 1
.end_amdhsa_kernel
.p2align 6
.amdhsa_kernel gemm1_kernel
  .amdhsa_next_free_vgpr 256
  .amdhsa_next_free_sgpr 80
  .amdhsa_accum_offset 128
  .amdhsa_group_segment_fixed_size 0
  .amdhsa_kernarg_size 128
  .amdhsa_user_sgpr_count 2
  .amdhsa_user_sgpr_kernarg_segment_ptr 1
  .amdhsa_system_sgpr_workgroup_id_x 1
.end_amdhsa_kernel
```
